```python
import torch

def _softmax(x, axis=-1):
    return torch.softmax(x, dim=axis)
def _gelu(x):
    return torch.nn.functional.gelu(x, approximate="tanh")
def _silu(x):
    return torch.nn.functional.silu(x)
def _sigmoid(x):
    return torch.sigmoid(x)
def _layernorm(x, axis=-1, eps=1e-5):
    m = x.mean(dim=axis, keepdim=True)
    v = x.var(dim=axis, keepdim=True, unbiased=False)
    return (x - m) / torch.sqrt(v + eps)
def _scatter_add(tgt, idx, src, axis=0):
    return tgt.clone().index_add_(axis, idx, src)
def _segment_sum(src, seg, n):
    out = torch.zeros((n,) + src.shape[1:], dtype=src.dtype)
    return out.index_add_(0, seg, src)
def _pad(x, pw):
    flat = tuple(v for pair in reversed(pw) for v in pair)
    return torch.nn.functional.pad(x, flat)

kernel_name = 'recurrent_scan__ssm_conv_s4d__dense_activation_silu__prompt'

def setup_inputs():

    _w = (lambda a: (lambda t: t.to(torch.bfloat16) if t.is_floating_point() else t)(torch.as_tensor(a)))
    def _A_setup():
        Bsz, L, D, N = 1, 2048, 512, 128
        return {
            "u": _w((lambda *s: torch.randn(*s, dtype=torch.bfloat16) * 0.05)(Bsz, L, D)),
            "log_A_real": _w((lambda *s: torch.randn(*s, dtype=torch.bfloat16) * 6.4)(D, N) * 0.5),
            "A_imag": _w((lambda *s: torch.randn(*s, dtype=torch.bfloat16) * 0.2)(D, N) * 3.14),
            "C_real": _w((lambda *s: torch.randn(*s, dtype=torch.bfloat16) * 0.4)(D, N) / N ** 0.5),
            "C_imag": _w((lambda *s: torch.randn(*s, dtype=torch.bfloat16) * 0.4)(D, N) / N ** 0.5),
            "log_dt": _w((lambda *s: torch.randn(*s, dtype=torch.bfloat16) * 0.2)(D) * 0.5 - 4.0),
            "D_skip": _w((lambda *s: torch.randn(*s, dtype=torch.bfloat16) * 0.2)(D)),
        }
    _A_in = _A_setup()

    def _B_setup():
        B, S, D, F = 1, 2048, 512, 1792
        return {
            "x": _w((lambda *s: torch.randn(*s, dtype=torch.bfloat16) * 0.05)(B, S, D)),
            "w1": _w((lambda *s: torch.randn(*s, dtype=torch.bfloat16) * 0.8)(D, F) * (D ** -0.5)),
            "w2": _w((lambda *s: torch.randn(*s, dtype=torch.bfloat16) * 0.1)(F, D) * (F ** -0.5)),
        }
    _B_in = _B_setup()

    return {
        "A_u": _A_in["u"],
        "A_log_A_real": _A_in["log_A_real"],
        "A_A_imag": _A_in["A_imag"],
        "A_C_real": _A_in["C_real"],
        "A_C_imag": _A_in["C_imag"],
        "A_log_dt": _A_in["log_dt"],
        "A_D_skip": _A_in["D_skip"],
        "B_x": _B_in["x"],
        "B_w1": _B_in["w1"],
        "B_w2": _B_in["w2"],
    }

def reference(A_u, A_log_A_real, A_A_imag, A_C_real, A_C_imag, A_log_dt, A_D_skip, B_x, B_w1, B_w2):
    def _A_ref(u, log_A_real, A_imag, C_real, C_imag, log_dt, D_skip):
        L = u.shape[1]
        dt = torch.exp(log_dt)
        A = -torch.exp(log_A_real) + 1j * A_imag
        C = (C_real + 1j * C_imag) * dt[:, None]
        pos = (lambda x, dt: x.to(dt))(torch.arange(L), log_dt.dtype)
        P = torch.exp((A * dt[:, None])[:, :, None] * pos[None, None, :])
        K = 2.0 * torch.einsum("dn,dnl->dl", C, P).real
        L2 = 2 * L
        u_t = (lambda x, *d: x.permute(*d))(u, 0, 2, 1)
        Kf = (lambda x, *a, **k: torch.fft.rfft(x.float(), *a, **k))(K, L2)
        Uf = (lambda x, *a, **k: torch.fft.rfft(x.float(), *a, **k))(u_t, L2)
        y = (lambda x, *a, **k: torch.fft.irfft(x, *a, **k).to(torch.bfloat16))(Uf * Kf[None, :, :], L2)[:, :, :L]
        y = (lambda x, *d: x.permute(*d))(y, 0, 2, 1)
        return y + u * D_skip[None, None, :]

    def _B_ref(x, w1, w2):
        h = torch.einsum("bsd,df->bsf", x, w1)
        h = _silu(h)
        out = torch.einsum("bsf,fd->bsd", h, w2)
        return out

    x = A_u
    xn = _layernorm(x, axis=-1)
    s = _A_ref(xn, A_log_A_real, A_A_imag, A_C_real, A_C_imag, A_log_dt, A_D_skip)
    g = _silu(_B_ref(xn, B_w1, B_w2))
    return x + s * g
```

```asm
; @launch grid=(256,1,1) block=(512,1,1) lds=163840
.amdgcn_target "amdgcn-amd-amdhsa--gfx950"
.text
.p2align 8
.globl recurrent_scan__ssm_conv_s4d__dense_activation_silu__prompt_kernel
.type recurrent_scan__ssm_conv_s4d__dense_activation_silu__prompt_kernel,@function
recurrent_scan__ssm_conv_s4d__dense_activation_silu__prompt_kernel:
    s_cmp_ge_u32 s2, 256
    s_cbranch_scc1 L_END
    s_load_dwordx16 s[16:31], s[0:1], 0
    s_load_dwordx8 s[32:39], s[0:1], 64
    s_load_dwordx2 s[40:41], s[0:1], 96
    s_getpc_b64 s[42:43]
L_PC0:
    v_lshlrev_b32 v2, 7, v0
    v_cmp_gt_u32 vcc, L_CODE_END-L_PC0, v2
    s_nop 0
    s_and_saveexec_b64 s[66:67], vcc
    s_cbranch_execz L_NOCPF
    global_load_dword v159, v2, s[42:43]
L_NOCPF:
    s_mov_b64 exec, -1
    v_lshrrev_b32 v2, 6, v0
    v_and_b32 v1, 63, v0
    v_readfirstlane_b32 s52, v2
    s_bfe_u32 s55, s2, 0x20001
    s_lshl_b32 s55, s55, 2
    s_bfe_u32 s56, s2, 0x20003
    s_add_u32 s53, s55, s56
    s_and_b32 s55, s2, 1
    s_lshl_b32 s55, s55, 3
    s_lshr_b32 s64, s2, 5
    s_add_u32 s54, s55, s64
    s_lshl_b32 s57, s56, 1
    s_add_u32 s59, s57, s64
    s_and_b32 s58, s54, 1
    s_and_b32 s55, s2, 7
    s_lshl_b32 s63, s55, 2
    s_add_u32 s63, s63, s56
    s_lshl_b32 s60, s55, 5
    s_lshr_b32 s55, s2, 3
    s_add_u32 s60, s60, s55
    s_mul_i32 s3, s64, 14
    s_lshr_b32 s3, s3, 3
    s_mul_i32 s55, s56, 7
    s_lshr_b32 s55, s55, 1
    s_add_u32 s3, s3, s55
    s_sub_u32 s55, s3, 14
    s_cmp_ge_u32 s3, 14
    s_cselect_b32 s3, s55, s3
    v_lshlrev_b32 v2, 2, v1
    v_add_u32 v2, 163328, v2
    v_mov_b32 v14, 0
    ds_write_b32 v2, v14
    s_cmp_lt_u32 s52, 4
    s_nop 0
    s_cbranch_scc0 L_M
L_H:
    s_lshr_b32 s55, s52, 1
    s_lshl_b32 s57, s60, 1
    s_add_u32 s57, s57, s55
    s_and_b32 s56, s52, 1
    s_lshl_b32 s56, s56, 7
    s_lshl_b32 s55, s57, 8
    s_add_u32 s55, s55, s56
    v_lshl_add_u32 v100, v1, 1, s55
    v_xor_b32 v101, 128, v100
    s_lshl_b32 s55, s57, 1
    v_mov_b32 v102, s55
    v_lshrrev_b32 v36, 3, v1
    v_lshrrev_b32 v37, 4, v1
    v_and_b32 v38, 7, v1
    v_xor_b32 v38, v38, v37
    v_lshlrev_b32 v38, 4, v38
    v_lshl_add_u32 v16, v36, 10, v38
    v_xor_b32 v39, 64, v16
    v_add_u32 v17, 7168, v39
    v_add_u32 v18, 14336, v16
    v_add_u32 v19, 21504, v39
    v_bfe_u32 v36, v1, 1, 3
    v_xor_b32 v36, v36, v37
    v_xor_b32 v36, 0, v36
    v_and_b32 v38, 1, v1
    v_lshl_add_u32 v38, v36, 1, v38
    s_lshl_b32 s55, s58, 1
    v_add_u32 v38, s55, v38
    v_subrev_u32 v39, 14, v38
    v_cmp_gt_u32 vcc, 14, v38
    s_nop 1
    v_cndmask_b32 v38, v39, v38, vcc
    v_lshlrev_b32 v38, 4, v38
    v_mul_u32_u24 v39, 3584, v37
    v_add_u32 v38, v38, v39
    v_mov_b32 v39, 0x7f000000
    v_cmp_eq_u32 vcc, 7, v36
    s_nop 1
    v_cndmask_b32 v38, v38, v39, vcc
    v_add_u32 v20, 0, v38
    v_add_u32 v21, 13312, v38
    v_bfe_u32 v36, v1, 1, 3
    v_xor_b32 v36, v36, v37
    v_xor_b32 v36, 4, v36
    v_and_b32 v38, 1, v1
    v_lshl_add_u32 v38, v36, 1, v38
    s_lshl_b32 s55, s58, 1
    v_add_u32 v38, s55, v38
    v_subrev_u32 v39, 14, v38
    v_cmp_gt_u32 vcc, 14, v38
    s_nop 1
    v_cndmask_b32 v38, v39, v38, vcc
    v_lshlrev_b32 v38, 4, v38
    v_mul_u32_u24 v39, 3584, v37
    v_add_u32 v38, v38, v39
    v_mov_b32 v39, 0x7f000000
    v_cmp_eq_u32 vcc, 7, v36
    s_nop 1
    v_cndmask_b32 v38, v38, v39, vcc
    v_add_u32 v22, 26624, v38
    v_add_u32 v23, 39936, v38
    s_lshl_b32 s65, s53, 17
    s_lshl_b32 s55, s52, 15
    s_add_u32 s65, s65, s55
    s_mul_i32 s66, s52, 57344
    s_mul_i32 s55, s54, 224
    s_add_u32 s66, s66, s55
    s_lshl_b32 s67, s52, 12
    v_lshlrev_b32 v13, 4, v1
    s_waitcnt lgkmcnt(0)
    global_load_ushort v70, v102, s[26:27]
    global_load_ushort v64, v100, s[18:19]
    global_load_ushort v65, v100, s[20:21]
    global_load_ushort v66, v100, s[22:23]
    global_load_ushort v67, v100, s[24:25]
    global_load_ushort v68, v101, s[22:23]
    global_load_ushort v69, v101, s[24:25]
    s_mov_b32 s4, s16
    s_and_b32 s5, s17, 0xffff
    s_mov_b32 s6, 0x200000
    s_mov_b32 s7, 0x00020000
    s_mov_b32 s8, s32
    s_and_b32 s9, s33, 0xffff
    s_mov_b32 s10, 0x1c0000
    s_mov_b32 s11, 0x00020000
    s_barrier
    s_add_u32 s17, s59, 0
    s_and_b32 s17, s17, 7
    s_lshl_b32 s28, s17, 7
    s_add_u32 s28, s28, s65
    s_add_u32 m0, s67, 0
    s_mul_i32 s29, s17, 229376
    s_add_u32 s29, s29, s66
    buffer_load_dwordx4 v16, s[4:7], s28 offen offset:0 lds
    buffer_load_dwordx4 v17, s[4:7], s28 offen offset:1024 lds
    buffer_load_dwordx4 v18, s[4:7], s28 offen offset:2048 lds
    buffer_load_dwordx4 v19, s[4:7], s28 offen offset:3072 lds
    s_add_u32 m0, s67, 65536
    s_nop 0
    buffer_load_dwordx4 v20, s[8:11], s29 offen offset:0 lds
    buffer_load_dwordx4 v21, s[8:11], s29 offen offset:1024 lds
    buffer_load_dwordx4 v22, s[8:11], s29 offen offset:2048 lds
    buffer_load_dwordx4 v23, s[8:11], s29 offen offset:3072 lds
    v_lshrrev_b32 v36, 2, v1
    v_mul_u32_u24 v36, 3584, v36
    v_and_b32 v37, 3, v1
    v_mul_u32_u24 v37, 72, v37
    v_add_u32 v36, v36, v37
    s_add_u32 s55, s59, 1
    s_and_b32 s55, s55, 7
    s_mul_i32 s55, s55, 229376
    s_add_u32 s55, s55, s66
    buffer_load_dword v47, v36, s[8:11], s55 offen
    s_branch L_H2
L_M:
    s_sub_u32 s52, s52, 4
    v_lshlrev_b32 v19, 21, v1
    v_lshlrev_b32 v187, 4, v1
    v_mov_b32 v188, 13657088
    s_lshl_b32 s55, s60, 13
    s_lshl_b32 s56, s52, 11
    s_add_u32 s55, s55, s56
    v_add_u32 v186, s55, v187
    s_lshl_b32 s55, s2, 2
    s_add_u32 s55, s55, s52
    s_mul_i32 s55, s55, 1792
    v_lshl_add_u32 v185, v1, 7, s55
    s_waitcnt lgkmcnt(0)
    global_load_dword v188, v188, s[40:41] sc1
    global_load_dwordx4 v[160:163], v186, s[16:17]
    global_load_dwordx4 v[164:167], v186, s[16:17] offset:1024
    s_mov_b32 s12, s40
    s_and_b32 s13, s41, 0xffff
    s_mov_b32 s14, 0xe00000
    s_mov_b32 s15, 0x00020000
    s_mov_b32 s4, s16
    s_and_b32 s5, s17, 0xffff
    s_mov_b32 s6, 0x200000
    s_mov_b32 s7, 0x00020000
    s_mov_b32 s48, s36
    s_and_b32 s49, s37, 0xffff
    s_mov_b32 s50, 0x200000
    s_mov_b32 s51, 0x00020000
    s_mov_b64 exec, 0x7f
    buffer_load_dword v156, v19, s[12:15], 0 offen
    s_mov_b64 exec, 1
    global_load_dword v157, v19, s[36:37]
    s_mov_b64 exec, 1
    global_load_dword v158, v185, s[34:35]
    s_mov_b64 exec, -1
    s_barrier
    s_lshl_b32 s55, s60, 2
    s_load_dword s68, s[28:29], s55
    v_and_b32 v16, 15, v1
    v_lshrrev_b32 v17, 4, v1
    v_lshrrev_b32 v18, 1, v16
    v_xor_b32 v18, v18, v17
    v_lshlrev_b32 v18, 4, v18
    v_lshl_add_u32 v18, v16, 7, v18
    s_lshl_b32 s55, s52, 12
    v_add_u32 v4, s55, v18
    v_xor_b32 v5, 64, v4
    v_lshrrev_b32 v16, 4, v1
    v_bfe_u32 v17, v1, 2, 2
    v_and_b32 v18, 1, v16
    v_lshl_or_b32 v18, v18, 2, v17
    v_lshl_add_u32 v16, v16, 3, v17
    v_and_b32 v17, 3, v1
    v_lshlrev_b32 v17, 3, v17
    v_lshl_add_u32 v19, v16, 8, v17
    v_add_u32 v19, 65536, v19
    v_xor_b32 v16, 0, v18
    v_lshl_add_u32 v6, v16, 5, v19
    v_xor_b32 v16, 1, v18
    v_lshl_add_u32 v7, v16, 5, v19
    v_xor_b32 v16, 2, v18
    v_lshl_add_u32 v8, v16, 5, v19
    v_xor_b32 v16, 3, v18
    v_lshl_add_u32 v9, v16, 5, v19
    v_xor_b32 v16, 4, v18
    v_lshl_add_u32 v10, v16, 5, v19
    v_xor_b32 v16, 5, v18
    v_lshl_add_u32 v11, v16, 5, v19
    v_xor_b32 v16, 6, v18
    v_lshl_add_u32 v12, v16, 5, v19
    v_mov_b32 v184, 0x3f803f80
    s_waitcnt lgkmcnt(0)
    s_waitcnt vmcnt(3)
    v_dot2_f32_bf16 v168, v160, v184, 0
    v_dot2_f32_bf16 v170, v160, v160, 0
    v_dot2_f32_bf16 v168, v161, v184, v168
    v_dot2_f32_bf16 v170, v161, v161, v170
    v_dot2_f32_bf16 v168, v162, v184, v168
    v_dot2_f32_bf16 v170, v162, v162, v170
    v_dot2_f32_bf16 v168, v163, v184, v168
    v_dot2_f32_bf16 v170, v163, v163, v170
    v_dot2_f32_bf16 v169, v164, v184, 0
    v_dot2_f32_bf16 v171, v164, v164, 0
    v_dot2_f32_bf16 v169, v165, v184, v169
    v_dot2_f32_bf16 v171, v165, v165, v171
    v_dot2_f32_bf16 v169, v166, v184, v169
    v_dot2_f32_bf16 v171, v166, v166, v171
    v_dot2_f32_bf16 v169, v167, v184, v169
    v_dot2_f32_bf16 v171, v167, v167, v171
    v_add_f32_dpp v168, v168, v168 row_ror:1 row_mask:0xf bank_mask:0xf
    s_nop 0
    v_add_f32_dpp v169, v169, v169 row_ror:1 row_mask:0xf bank_mask:0xf
    v_add_f32_dpp v170, v170, v170 row_ror:1 row_mask:0xf bank_mask:0xf
    v_add_f32_dpp v171, v171, v171 row_ror:1 row_mask:0xf bank_mask:0xf
    v_add_f32_dpp v168, v168, v168 row_ror:2 row_mask:0xf bank_mask:0xf
    v_add_f32_dpp v169, v169, v169 row_ror:2 row_mask:0xf bank_mask:0xf
    v_add_f32_dpp v170, v170, v170 row_ror:2 row_mask:0xf bank_mask:0xf
    v_add_f32_dpp v171, v171, v171 row_ror:2 row_mask:0xf bank_mask:0xf
    v_add_f32_dpp v168, v168, v168 row_ror:4 row_mask:0xf bank_mask:0xf
    v_add_f32_dpp v169, v169, v169 row_ror:4 row_mask:0xf bank_mask:0xf
    v_add_f32_dpp v170, v170, v170 row_ror:4 row_mask:0xf bank_mask:0xf
    v_add_f32_dpp v171, v171, v171 row_ror:4 row_mask:0xf bank_mask:0xf
    v_add_f32_dpp v168, v168, v168 row_ror:8 row_mask:0xf bank_mask:0xf
    v_add_f32_dpp v169, v169, v169 row_ror:8 row_mask:0xf bank_mask:0xf
    v_add_f32_dpp v170, v170, v170 row_ror:8 row_mask:0xf bank_mask:0xf
    v_add_f32_dpp v171, v171, v171 row_ror:8 row_mask:0xf bank_mask:0xf
    v_mov_b32 v172, v168
    v_mov_b32 v173, v169
    v_mov_b32 v174, v170
    v_mov_b32 v175, v171
    v_permlane16_swap_b32 v168, v172
    v_permlane16_swap_b32 v169, v173
    v_permlane16_swap_b32 v170, v174
    v_permlane16_swap_b32 v171, v175
    v_add_f32 v168, v168, v172
    v_add_f32 v169, v169, v173
    v_add_f32 v170, v170, v174
    v_add_f32 v171, v171, v175
    v_mov_b32 v172, v168
    v_mov_b32 v173, v169
    v_mov_b32 v174, v170
    v_mov_b32 v175, v171
    v_permlane32_swap_b32 v168, v172
    v_permlane32_swap_b32 v169, v173
    v_permlane32_swap_b32 v170, v174
    v_permlane32_swap_b32 v171, v175
    v_add_f32 v168, v168, v172
    v_add_f32 v169, v169, v173
    v_add_f32 v170, v170, v174
    v_add_f32 v171, v171, v175
    v_mul_f32 v168, 0x3b000000, v168
    v_mul_f32 v169, 0x3b000000, v169
    v_mul_f32 v170, 0x3b000000, v170
    v_mul_f32 v171, 0x3b000000, v171
    v_fma_f32 v170, -v168, v168, v170
    v_fma_f32 v171, -v169, v169, v171
    v_max_f32 v170, 0, v170
    v_max_f32 v171, 0, v171
    v_cvt_pk_bf16_f32 v170, v170, v170
    v_cvt_pk_bf16_f32 v171, v171, v171
    v_lshlrev_b32 v170, 16, v170
    v_lshlrev_b32 v171, 16, v171
    v_cvt_pk_bf16_f32 v168, v168, v168
    v_cvt_pk_bf16_f32 v169, v169, v169
    v_lshlrev_b32 v168, 16, v168
    v_lshlrev_b32 v169, 16, v169
    v_add_f32 v170, 0x3727c5ac, v170
    v_add_f32 v171, 0x3727c5ac, v171
    v_cvt_pk_bf16_f32 v170, v170, v170
    v_cvt_pk_bf16_f32 v171, v171, v171
    v_lshlrev_b32 v170, 16, v170
    v_lshlrev_b32 v171, 16, v171
    v_sqrt_f32 v170, v170
    v_sqrt_f32 v171, v171
    v_cvt_pk_bf16_f32 v170, v170, v170
    v_cvt_pk_bf16_f32 v171, v171, v171
    v_lshlrev_b32 v170, 16, v170
    v_lshlrev_b32 v171, 16, v171
    v_rcp_f32 v172, v170
    v_rcp_f32 v173, v171
    v_mul_f32_e64 v174, -v168, v172
    v_mul_f32_e64 v175, -v169, v173
    v_lshrrev_b32 v168, 16, v168
    v_lshrrev_b32 v169, 16, v169
    v_or_b32 v168, v168, v170
    v_or_b32 v169, v169, v171
    v_readfirstlane_b32 s61, v188
    v_mov_b32 v14, 163328
    v_mov_b32 v15, 1
    s_mul_i32 s61, s61, 0x9e3779b1
    s_add_u32 s61, s61, 0x7f4a7c15
    v_cmp_eq_u32 vcc, 1, v1
    s_nop 1
    v_cndmask_b32 v176, v168, v169, vcc
    v_mov_b32 v177, s61
    ds_write_b32 v14, v177 offset:32
    v_lshlrev_b32 v178, 16, v160
    v_and_b32 v179, 0xffff0000, v160
    v_fma_f32 v178, v178, v172, v174
    v_fma_f32 v179, v179, v172, v174
    v_cvt_pk_f16_f32 v160, v178, v179
    v_lshlrev_b32 v180, 16, v161
    v_and_b32 v181, 0xffff0000, v161
    v_fma_f32 v180, v180, v172, v174
    v_fma_f32 v181, v181, v172, v174
    v_cvt_pk_f16_f32 v161, v180, v181
    v_lshlrev_b32 v178, 16, v162
    v_and_b32 v179, 0xffff0000, v162
    v_fma_f32 v178, v178, v172, v174
    v_fma_f32 v179, v179, v172, v174
    v_cvt_pk_f16_f32 v162, v178, v179
    v_lshlrev_b32 v180, 16, v163
    v_and_b32 v181, 0xffff0000, v163
    v_fma_f32 v180, v180, v172, v174
    v_fma_f32 v181, v181, v172, v174
    v_cvt_pk_f16_f32 v163, v180, v181
    v_lshlrev_b32 v178, 16, v164
    v_and_b32 v179, 0xffff0000, v164
    v_fma_f32 v178, v178, v173, v175
    v_fma_f32 v179, v179, v173, v175
    v_cvt_pk_f16_f32 v164, v178, v179
    v_lshlrev_b32 v180, 16, v165
    v_and_b32 v181, 0xffff0000, v165
    v_fma_f32 v180, v180, v173, v175
    v_fma_f32 v181, v181, v173, v175
    v_cvt_pk_f16_f32 v165, v180, v181
    v_lshlrev_b32 v178, 16, v166
    v_and_b32 v179, 0xffff0000, v166
    v_fma_f32 v178, v178, v173, v175
    v_fma_f32 v179, v179, v173, v175
    v_cvt_pk_f16_f32 v166, v178, v179
    v_lshlrev_b32 v180, 16, v167
    v_and_b32 v181, 0xffff0000, v167
    v_fma_f32 v180, v180, v173, v175
    v_fma_f32 v181, v181, v173, v175
    v_cvt_pk_f16_f32 v167, v180, v181
    s_mul_i32 s55, s52, 2176
    s_add_u32 s55, s55, 147456
    v_add_u32 v16, s55, v187
    ds_write_b128 v16, v[160:163]
    ds_write_b128 v16, v[164:167] offset:1088
    s_mov_b64 exec, 1
    ds_add_u32 v14, v15 offset:48
    s_mov_b64 exec, -1
    v_bfe_u32 v16, v1, 2, 2
    v_mul_u32_u24 v16, 1088, v16
    v_lshrrev_b32 v17, 4, v1
    v_lshl_add_u32 v16, v17, 5, v16
    v_and_b32 v17, 3, v1
    v_lshl_add_u32 v16, v17, 3, v16
    s_lshl_b32 s55, s52, 8
    s_add_u32 s55, s55, 147456
    v_add_u32 v16, s55, v16
    s_mov_b32 s62, 0x1000000
    s_nop 1
L_WXN:
    ds_read_b32 v19, v14 offset:48
    s_waitcnt lgkmcnt(0)
    v_readfirstlane_b32 s55, v19
    s_sub_u32 s62, s62, 1
    s_cselect_b32 s55, 4, s55
    s_cmp_lt_u32 s55, 4
    s_cbranch_scc1 L_WXN
    ds_read_b64_tr_b16 v[160:161], v16 offset:0
    ds_read_b64_tr_b16 v[162:163], v16 offset:4352
    ds_read_b64_tr_b16 v[164:165], v16 offset:128
    ds_read_b64_tr_b16 v[166:167], v16 offset:4480
    v_lshlrev_b32 v16, 3, v1
    s_lshl_b32 s55, s60, 6
    s_lshl_b32 s56, s52, 4
    s_add_u32 s55, s55, s56
    s_add_u32 s55, s55, 13631488
    s_setprio 3
    s_mov_b64 exec, 3
    buffer_store_dwordx2 v[176:177], v16, s[12:15], s55 offen sc1
    s_mov_b64 exec, -1
    s_lshl_b32 s55, s60, 13
    s_lshl_b32 s56, s52, 11
    s_add_u32 s55, s55, s56
    s_add_u32 s55, s55, 7340032
    s_waitcnt lgkmcnt(0)
    buffer_store_dwordx4 v[160:163], v187, s[12:15], s55 offen sc1
    buffer_store_dwordx4 v[164:167], v187, s[12:15], s55 offen offset:1024 sc1
    s_waitcnt lgkmcnt(0)
    s_setprio 0
    s_barrier
    ds_read_b128 v[48:51], v4 offset:0
    ds_read_b128 v[52:55], v4 offset:2048
    ds_read_b64_tr_b16 v[20:21], v6 offset:0
    ds_read_b64_tr_b16 v[22:23], v6 offset:1024
    ds_read_b64_tr_b16 v[24:25], v7 offset:0
    ds_read_b64_tr_b16 v[26:27], v7 offset:1024
    ds_read_b64_tr_b16 v[28:29], v8 offset:0
    ds_read_b64_tr_b16 v[30:31], v8 offset:1024
    ds_read_b64_tr_b16 v[32:33], v9 offset:0
    ds_read_b64_tr_b16 v[34:35], v9 offset:1024
    ds_read_b64_tr_b16 v[36:37], v10 offset:0
    ds_read_b64_tr_b16 v[38:39], v10 offset:1024
    ds_read_b64_tr_b16 v[40:41], v11 offset:0
    ds_read_b64_tr_b16 v[42:43], v11 offset:1024
    ds_read_b64_tr_b16 v[44:45], v12 offset:0
    ds_read_b64_tr_b16 v[46:47], v12 offset:1024
    v_mov_b32 v3, s61
    s_waitcnt lgkmcnt(12)
    v_mfma_f32_16x16x32_bf16 v[92:95], v[20:23], v[48:51], 0
    ds_read_b128 v[84:87], v5 offset:0
    ds_read_b128 v[88:91], v5 offset:2048
    v_mfma_f32_16x16x32_bf16 v[96:99], v[20:23], v[52:55], 0
    ds_read_b64_tr_b16 v[56:57], v6 offset:8192
    s_waitcnt lgkmcnt(13)
    v_mfma_f32_16x16x32_bf16 v[100:103], v[24:27], v[48:51], 0
    ds_read_b64_tr_b16 v[58:59], v6 offset:9216
    v_mfma_f32_16x16x32_bf16 v[104:107], v[24:27], v[52:55], 0
    ds_read_b64_tr_b16 v[60:61], v7 offset:8192
    s_waitcnt lgkmcnt(13)
    v_mfma_f32_16x16x32_bf16 v[108:111], v[28:31], v[48:51], 0
    ds_read_b64_tr_b16 v[62:63], v7 offset:9216
    ds_read_b64_tr_b16 v[64:65], v8 offset:8192
    v_mfma_f32_16x16x32_bf16 v[112:115], v[28:31], v[52:55], 0
    ds_read_b64_tr_b16 v[66:67], v8 offset:9216
    s_waitcnt lgkmcnt(14)
    v_mfma_f32_16x16x32_bf16 v[116:119], v[32:35], v[48:51], 0
    ds_read_b64_tr_b16 v[68:69], v9 offset:8192
    v_mfma_f32_16x16x32_bf16 v[120:123], v[32:35], v[52:55], 0
    ds_read_b64_tr_b16 v[70:71], v9 offset:9216
    s_waitcnt lgkmcnt(14)
    v_mfma_f32_16x16x32_bf16 v[124:127], v[36:39], v[48:51], 0
    ds_read_b64_tr_b16 v[72:73], v10 offset:8192
    ds_read_b64_tr_b16 v[74:75], v10 offset:9216
    v_mfma_f32_16x16x32_bf16 v[128:131], v[36:39], v[52:55], 0
    ds_read_b64_tr_b16 v[76:77], v11 offset:8192
    s_waitcnt lgkmcnt(15)
    v_mfma_f32_16x16x32_bf16 v[132:135], v[40:43], v[48:51], 0
    ds_read_b64_tr_b16 v[78:79], v11 offset:9216
    v_mfma_f32_16x16x32_bf16 v[136:139], v[40:43], v[52:55], 0
    ds_read_b64_tr_b16 v[80:81], v12 offset:8192
    s_waitcnt lgkmcnt(15)
    v_mfma_f32_16x16x32_bf16 v[140:143], v[44:47], v[48:51], 0
    ds_read_b64_tr_b16 v[82:83], v12 offset:9216
    v_mfma_f32_16x16x32_bf16 v[144:147], v[44:47], v[52:55], 0
    s_waitcnt lgkmcnt(12)
    v_mfma_f32_16x16x32_bf16 v[92:95], v[56:59], v[84:87], v[92:95]
    v_mfma_f32_16x16x32_bf16 v[96:99], v[56:59], v[88:91], v[96:99]
    s_waitcnt lgkmcnt(10)
    v_mfma_f32_16x16x32_bf16 v[100:103], v[60:63], v[84:87], v[100:103]
    v_mfma_f32_16x16x32_bf16 v[104:107], v[60:63], v[88:91], v[104:107]
    s_waitcnt lgkmcnt(8)
    s_waitcnt lgkmcnt(0)
    s_barrier
    v_mfma_f32_16x16x32_bf16 v[108:111], v[64:67], v[84:87], v[108:111]
    ds_read_b128 v[48:51], v4 offset:16384
    ds_read_b128 v[52:55], v4 offset:18432
    v_mfma_f32_16x16x32_bf16 v[112:115], v[64:67], v[88:91], v[112:115]
    ds_read_b64_tr_b16 v[20:21], v6 offset:16384
    ds_read_b64_tr_b16 v[22:23], v6 offset:17408
    v_mfma_f32_16x16x32_bf16 v[116:119], v[68:71], v[84:87], v[116:119]
    ds_read_b64_tr_b16 v[24:25], v7 offset:16384
    ds_read_b64_tr_b16 v[26:27], v7 offset:17408
    v_mfma_f32_16x16x32_bf16 v[120:123], v[68:71], v[88:91], v[120:123]
    ds_read_b64_tr_b16 v[28:29], v8 offset:16384
    ds_read_b64_tr_b16 v[30:31], v8 offset:17408
    v_mfma_f32_16x16x32_bf16 v[124:127], v[72:75], v[84:87], v[124:127]
    ds_read_b64_tr_b16 v[32:33], v9 offset:16384
    v_mfma_f32_16x16x32_bf16 v[128:131], v[72:75], v[88:91], v[128:131]
    ds_read_b64_tr_b16 v[34:35], v9 offset:17408
    ds_read_b64_tr_b16 v[36:37], v10 offset:16384
    v_mfma_f32_16x16x32_bf16 v[132:135], v[76:79], v[84:87], v[132:135]
    ds_read_b64_tr_b16 v[38:39], v10 offset:17408
    ds_read_b64_tr_b16 v[40:41], v11 offset:16384
    v_mfma_f32_16x16x32_bf16 v[136:139], v[76:79], v[88:91], v[136:139]
    ds_read_b64_tr_b16 v[42:43], v11 offset:17408
    ds_read_b64_tr_b16 v[44:45], v12 offset:16384
    v_mfma_f32_16x16x32_bf16 v[140:143], v[80:83], v[84:87], v[140:143]
    ds_read_b64_tr_b16 v[46:47], v12 offset:17408
    v_mfma_f32_16x16x32_bf16 v[144:147], v[80:83], v[88:91], v[144:147]
    s_lshl_b32 s56, s60, 2
    s_lshl_b32 s55, s52, 10
    s_add_u32 s56, s56, s55
    s_add_u32 s56, s56, 13647872
    v_mov_b32 v16, 0
    s_waitcnt vmcnt(0)
    s_setprio 3
    s_mov_b64 exec, 1
    buffer_store_dword v3, v16, s[12:15], s56 offen sc1
    s_mov_b64 exec, -1
    s_setprio 0
    s_waitcnt lgkmcnt(12)
    v_mfma_f32_16x16x32_bf16 v[92:95], v[20:23], v[48:51], v[92:95]
    ds_read_b128 v[84:87], v5 offset:16384
    ds_read_b128 v[88:91], v5 offset:18432
    v_mfma_f32_16x16x32_bf16 v[96:99], v[20:23], v[52:55], v[96:99]
    ds_read_b64_tr_b16 v[56:57], v6 offset:24576
    s_waitcnt lgkmcnt(13)
    v_mfma_f32_16x16x32_bf16 v[100:103], v[24:27], v[48:51], v[100:103]
    ds_read_b64_tr_b16 v[58:59], v6 offset:25600
    v_mfma_f32_16x16x32_bf16 v[104:107], v[24:27], v[52:55], v[104:107]
    ds_read_b64_tr_b16 v[60:61], v7 offset:24576
    s_waitcnt lgkmcnt(13)
    v_mfma_f32_16x16x32_bf16 v[108:111], v[28:31], v[48:51], v[108:111]
    ds_read_b64_tr_b16 v[62:63], v7 offset:25600
    ds_read_b64_tr_b16 v[64:65], v8 offset:24576
    v_mfma_f32_16x16x32_bf16 v[112:115], v[28:31], v[52:55], v[112:115]
    ds_read_b64_tr_b16 v[66:67], v8 offset:25600
    s_waitcnt lgkmcnt(14)
    v_mfma_f32_16x16x32_bf16 v[116:119], v[32:35], v[48:51], v[116:119]
    ds_read_b64_tr_b16 v[68:69], v9 offset:24576
    v_mfma_f32_16x16x32_bf16 v[120:123], v[32:35], v[52:55], v[120:123]
    ds_read_b64_tr_b16 v[70:71], v9 offset:25600
    s_waitcnt lgkmcnt(14)
    v_mfma_f32_16x16x32_bf16 v[124:127], v[36:39], v[48:51], v[124:127]
    ds_read_b64_tr_b16 v[72:73], v10 offset:24576
    ds_read_b64_tr_b16 v[74:75], v10 offset:25600
    v_mfma_f32_16x16x32_bf16 v[128:131], v[36:39], v[52:55], v[128:131]
    ds_read_b64_tr_b16 v[76:77], v11 offset:24576
    s_waitcnt lgkmcnt(15)
    v_mfma_f32_16x16x32_bf16 v[132:135], v[40:43], v[48:51], v[132:135]
    ds_read_b64_tr_b16 v[78:79], v11 offset:25600
    v_mfma_f32_16x16x32_bf16 v[136:139], v[40:43], v[52:55], v[136:139]
    ds_read_b64_tr_b16 v[80:81], v12 offset:24576
    s_waitcnt lgkmcnt(15)
    v_mfma_f32_16x16x32_bf16 v[140:143], v[44:47], v[48:51], v[140:143]
    ds_read_b64_tr_b16 v[82:83], v12 offset:25600
    v_mfma_f32_16x16x32_bf16 v[144:147], v[44:47], v[52:55], v[144:147]
    s_waitcnt lgkmcnt(12)
    v_mfma_f32_16x16x32_bf16 v[92:95], v[56:59], v[84:87], v[92:95]
    v_mfma_f32_16x16x32_bf16 v[96:99], v[56:59], v[88:91], v[96:99]
    s_waitcnt lgkmcnt(10)
    v_mfma_f32_16x16x32_bf16 v[100:103], v[60:63], v[84:87], v[100:103]
    v_mfma_f32_16x16x32_bf16 v[104:107], v[60:63], v[88:91], v[104:107]
    s_waitcnt lgkmcnt(8)
    s_waitcnt lgkmcnt(0)
    s_barrier
    v_mfma_f32_16x16x32_bf16 v[108:111], v[64:67], v[84:87], v[108:111]
    ds_read_b128 v[48:51], v4 offset:32768
    ds_read_b128 v[52:55], v4 offset:34816
    v_mfma_f32_16x16x32_bf16 v[112:115], v[64:67], v[88:91], v[112:115]
    ds_read_b64_tr_b16 v[20:21], v6 offset:32768
    ds_read_b64_tr_b16 v[22:23], v6 offset:33792
    v_mfma_f32_16x16x32_bf16 v[116:119], v[68:71], v[84:87], v[116:119]
    ds_read_b64_tr_b16 v[24:25], v7 offset:32768
    ds_read_b64_tr_b16 v[26:27], v7 offset:33792
    v_mfma_f32_16x16x32_bf16 v[120:123], v[68:71], v[88:91], v[120:123]
    ds_read_b64_tr_b16 v[28:29], v8 offset:32768
    ds_read_b64_tr_b16 v[30:31], v8 offset:33792
    v_mfma_f32_16x16x32_bf16 v[124:127], v[72:75], v[84:87], v[124:127]
    ds_read_b64_tr_b16 v[32:33], v9 offset:32768
    v_mfma_f32_16x16x32_bf16 v[128:131], v[72:75], v[88:91], v[128:131]
    ds_read_b64_tr_b16 v[34:35], v9 offset:33792
    ds_read_b64_tr_b16 v[36:37], v10 offset:32768
    v_mfma_f32_16x16x32_bf16 v[132:135], v[76:79], v[84:87], v[132:135]
    ds_read_b64_tr_b16 v[38:39], v10 offset:33792
    ds_read_b64_tr_b16 v[40:41], v11 offset:32768
    v_mfma_f32_16x16x32_bf16 v[136:139], v[76:79], v[88:91], v[136:139]
    ds_read_b64_tr_b16 v[42:43], v11 offset:33792
    ds_read_b64_tr_b16 v[44:45], v12 offset:32768
    v_mfma_f32_16x16x32_bf16 v[140:143], v[80:83], v[84:87], v[140:143]
    ds_read_b64_tr_b16 v[46:47], v12 offset:33792
    v_mfma_f32_16x16x32_bf16 v[144:147], v[80:83], v[88:91], v[144:147]
    s_waitcnt lgkmcnt(12)
    v_mfma_f32_16x16x32_bf16 v[92:95], v[20:23], v[48:51], v[92:95]
    ds_read_b128 v[84:87], v5 offset:32768
    ds_read_b128 v[88:91], v5 offset:34816
    v_mfma_f32_16x16x32_bf16 v[96:99], v[20:23], v[52:55], v[96:99]
    ds_read_b64_tr_b16 v[56:57], v6 offset:40960
    s_waitcnt lgkmcnt(13)
    v_mfma_f32_16x16x32_bf16 v[100:103], v[24:27], v[48:51], v[100:103]
    ds_read_b64_tr_b16 v[58:59], v6 offset:41984
    v_mfma_f32_16x16x32_bf16 v[104:107], v[24:27], v[52:55], v[104:107]
    ds_read_b64_tr_b16 v[60:61], v7 offset:40960
    s_waitcnt lgkmcnt(13)
    v_mfma_f32_16x16x32_bf16 v[108:111], v[28:31], v[48:51], v[108:111]
    ds_read_b64_tr_b16 v[62:63], v7 offset:41984
    ds_read_b64_tr_b16 v[64:65], v8 offset:40960
    v_mfma_f32_16x16x32_bf16 v[112:115], v[28:31], v[52:55], v[112:115]
    ds_read_b64_tr_b16 v[66:67], v8 offset:41984
    s_waitcnt lgkmcnt(14)
    v_mfma_f32_16x16x32_bf16 v[116:119], v[32:35], v[48:51], v[116:119]
    ds_read_b64_tr_b16 v[68:69], v9 offset:40960
    v_mfma_f32_16x16x32_bf16 v[120:123], v[32:35], v[52:55], v[120:123]
    ds_read_b64_tr_b16 v[70:71], v9 offset:41984
    s_waitcnt lgkmcnt(14)
    v_mfma_f32_16x16x32_bf16 v[124:127], v[36:39], v[48:51], v[124:127]
    ds_read_b64_tr_b16 v[72:73], v10 offset:40960
    ds_read_b64_tr_b16 v[74:75], v10 offset:41984
    v_mfma_f32_16x16x32_bf16 v[128:131], v[36:39], v[52:55], v[128:131]
    ds_read_b64_tr_b16 v[76:77], v11 offset:40960
    s_waitcnt lgkmcnt(15)
    v_mfma_f32_16x16x32_bf16 v[132:135], v[40:43], v[48:51], v[132:135]
    ds_read_b64_tr_b16 v[78:79], v11 offset:41984
    v_mfma_f32_16x16x32_bf16 v[136:139], v[40:43], v[52:55], v[136:139]
    ds_read_b64_tr_b16 v[80:81], v12 offset:40960
    s_waitcnt lgkmcnt(15)
    v_mfma_f32_16x16x32_bf16 v[140:143], v[44:47], v[48:51], v[140:143]
    ds_read_b64_tr_b16 v[82:83], v12 offset:41984
    v_mfma_f32_16x16x32_bf16 v[144:147], v[44:47], v[52:55], v[144:147]
    s_waitcnt lgkmcnt(12)
    v_mfma_f32_16x16x32_bf16 v[92:95], v[56:59], v[84:87], v[92:95]
    v_mfma_f32_16x16x32_bf16 v[96:99], v[56:59], v[88:91], v[96:99]
    s_waitcnt lgkmcnt(10)
    v_mfma_f32_16x16x32_bf16 v[100:103], v[60:63], v[84:87], v[100:103]
    v_mfma_f32_16x16x32_bf16 v[104:107], v[60:63], v[88:91], v[104:107]
    s_waitcnt lgkmcnt(8)
    s_waitcnt lgkmcnt(0)
    s_barrier
    v_mfma_f32_16x16x32_bf16 v[108:111], v[64:67], v[84:87], v[108:111]
    ds_read_b128 v[48:51], v4 offset:49152
    ds_read_b128 v[52:55], v4 offset:51200
    v_mfma_f32_16x16x32_bf16 v[112:115], v[64:67], v[88:91], v[112:115]
    ds_read_b64_tr_b16 v[20:21], v6 offset:49152
    ds_read_b64_tr_b16 v[22:23], v6 offset:50176
    v_mfma_f32_16x16x32_bf16 v[116:119], v[68:71], v[84:87], v[116:119]
    ds_read_b64_tr_b16 v[24:25], v7 offset:49152
    ds_read_b64_tr_b16 v[26:27], v7 offset:50176
    v_mfma_f32_16x16x32_bf16 v[120:123], v[68:71], v[88:91], v[120:123]
    ds_read_b64_tr_b16 v[28:29], v8 offset:49152
    ds_read_b64_tr_b16 v[30:31], v8 offset:50176
    v_mfma_f32_16x16x32_bf16 v[124:127], v[72:75], v[84:87], v[124:127]
    ds_read_b64_tr_b16 v[32:33], v9 offset:49152
    v_mfma_f32_16x16x32_bf16 v[128:131], v[72:75], v[88:91], v[128:131]
    ds_read_b64_tr_b16 v[34:35], v9 offset:50176
    ds_read_b64_tr_b16 v[36:37], v10 offset:49152
    v_mfma_f32_16x16x32_bf16 v[132:135], v[76:79], v[84:87], v[132:135]
    ds_read_b64_tr_b16 v[38:39], v10 offset:50176
    ds_read_b64_tr_b16 v[40:41], v11 offset:49152
    v_mfma_f32_16x16x32_bf16 v[136:139], v[76:79], v[88:91], v[136:139]
    ds_read_b64_tr_b16 v[42:43], v11 offset:50176
    ds_read_b64_tr_b16 v[44:45], v12 offset:49152
    v_mfma_f32_16x16x32_bf16 v[140:143], v[80:83], v[84:87], v[140:143]
    ds_read_b64_tr_b16 v[46:47], v12 offset:50176
    v_mfma_f32_16x16x32_bf16 v[144:147], v[80:83], v[88:91], v[144:147]
    s_waitcnt lgkmcnt(12)
    v_mfma_f32_16x16x32_bf16 v[92:95], v[20:23], v[48:51], v[92:95]
    ds_read_b128 v[84:87], v5 offset:49152
    ds_read_b128 v[88:91], v5 offset:51200
    v_mfma_f32_16x16x32_bf16 v[96:99], v[20:23], v[52:55], v[96:99]
    ds_read_b64_tr_b16 v[56:57], v6 offset:57344
    s_waitcnt lgkmcnt(13)
    v_mfma_f32_16x16x32_bf16 v[100:103], v[24:27], v[48:51], v[100:103]
    ds_read_b64_tr_b16 v[58:59], v6 offset:58368
    v_mfma_f32_16x16x32_bf16 v[104:107], v[24:27], v[52:55], v[104:107]
    ds_read_b64_tr_b16 v[60:61], v7 offset:57344
    s_waitcnt lgkmcnt(13)
    v_mfma_f32_16x16x32_bf16 v[108:111], v[28:31], v[48:51], v[108:111]
    ds_read_b64_tr_b16 v[62:63], v7 offset:58368
    ds_read_b64_tr_b16 v[64:65], v8 offset:57344
    v_mfma_f32_16x16x32_bf16 v[112:115], v[28:31], v[52:55], v[112:115]
    ds_read_b64_tr_b16 v[66:67], v8 offset:58368
    s_waitcnt lgkmcnt(14)
    v_mfma_f32_16x16x32_bf16 v[116:119], v[32:35], v[48:51], v[116:119]
    ds_read_b64_tr_b16 v[68:69], v9 offset:57344
    v_mfma_f32_16x16x32_bf16 v[120:123], v[32:35], v[52:55], v[120:123]
    ds_read_b64_tr_b16 v[70:71], v9 offset:58368
    s_waitcnt lgkmcnt(14)
    v_mfma_f32_16x16x32_bf16 v[124:127], v[36:39], v[48:51], v[124:127]
    ds_read_b64_tr_b16 v[72:73], v10 offset:57344
    ds_read_b64_tr_b16 v[74:75], v10 offset:58368
    v_mfma_f32_16x16x32_bf16 v[128:131], v[36:39], v[52:55], v[128:131]
    ds_read_b64_tr_b16 v[76:77], v11 offset:57344
    s_waitcnt lgkmcnt(15)
    v_mfma_f32_16x16x32_bf16 v[132:135], v[40:43], v[48:51], v[132:135]
    ds_read_b64_tr_b16 v[78:79], v11 offset:58368
    v_mfma_f32_16x16x32_bf16 v[136:139], v[40:43], v[52:55], v[136:139]
    ds_read_b64_tr_b16 v[80:81], v12 offset:57344
    s_waitcnt lgkmcnt(15)
    v_mfma_f32_16x16x32_bf16 v[140:143], v[44:47], v[48:51], v[140:143]
    ds_read_b64_tr_b16 v[82:83], v12 offset:58368
    v_mfma_f32_16x16x32_bf16 v[144:147], v[44:47], v[52:55], v[144:147]
    s_waitcnt lgkmcnt(12)
    v_mfma_f32_16x16x32_bf16 v[92:95], v[56:59], v[84:87], v[92:95]
    v_mfma_f32_16x16x32_bf16 v[96:99], v[56:59], v[88:91], v[96:99]
    s_waitcnt lgkmcnt(10)
    v_mfma_f32_16x16x32_bf16 v[100:103], v[60:63], v[84:87], v[100:103]
    v_mfma_f32_16x16x32_bf16 v[104:107], v[60:63], v[88:91], v[104:107]
    s_waitcnt lgkmcnt(8)
    s_waitcnt lgkmcnt(0)
    s_barrier
    v_mfma_f32_16x16x32_bf16 v[108:111], v[64:67], v[84:87], v[108:111]
    ds_read_b128 v[48:51], v4 offset:0
    ds_read_b128 v[52:55], v4 offset:2048
    v_mfma_f32_16x16x32_bf16 v[112:115], v[64:67], v[88:91], v[112:115]
    ds_read_b64_tr_b16 v[20:21], v6 offset:0
    ds_read_b64_tr_b16 v[22:23], v6 offset:1024
    v_mfma_f32_16x16x32_bf16 v[116:119], v[68:71], v[84:87], v[116:119]
    ds_read_b64_tr_b16 v[24:25], v7 offset:0
    ds_read_b64_tr_b16 v[26:27], v7 offset:1024
    v_mfma_f32_16x16x32_bf16 v[120:123], v[68:71], v[88:91], v[120:123]
    ds_read_b64_tr_b16 v[28:29], v8 offset:0
    ds_read_b64_tr_b16 v[30:31], v8 offset:1024
    v_mfma_f32_16x16x32_bf16 v[124:127], v[72:75], v[84:87], v[124:127]
    ds_read_b64_tr_b16 v[32:33], v9 offset:0
    v_mfma_f32_16x16x32_bf16 v[128:131], v[72:75], v[88:91], v[128:131]
    ds_read_b64_tr_b16 v[34:35], v9 offset:1024
    ds_read_b64_tr_b16 v[36:37], v10 offset:0
    v_mfma_f32_16x16x32_bf16 v[132:135], v[76:79], v[84:87], v[132:135]
    ds_read_b64_tr_b16 v[38:39], v10 offset:1024
    ds_read_b64_tr_b16 v[40:41], v11 offset:0
    v_mfma_f32_16x16x32_bf16 v[136:139], v[76:79], v[88:91], v[136:139]
    ds_read_b64_tr_b16 v[42:43], v11 offset:1024
    ds_read_b64_tr_b16 v[44:45], v12 offset:0
    v_mfma_f32_16x16x32_bf16 v[140:143], v[80:83], v[84:87], v[140:143]
    ds_read_b64_tr_b16 v[46:47], v12 offset:1024
    v_mfma_f32_16x16x32_bf16 v[144:147], v[80:83], v[88:91], v[144:147]
    s_waitcnt lgkmcnt(12)
    v_mfma_f32_16x16x32_bf16 v[92:95], v[20:23], v[48:51], v[92:95]
    ds_read_b128 v[84:87], v5 offset:0
    ds_read_b128 v[88:91], v5 offset:2048
    v_mfma_f32_16x16x32_bf16 v[96:99], v[20:23], v[52:55], v[96:99]
    ds_read_b64_tr_b16 v[56:57], v6 offset:8192
    s_waitcnt lgkmcnt(13)
    v_mfma_f32_16x16x32_bf16 v[100:103], v[24:27], v[48:51], v[100:103]
    ds_read_b64_tr_b16 v[58:59], v6 offset:9216
    v_mfma_f32_16x16x32_bf16 v[104:107], v[24:27], v[52:55], v[104:107]
    ds_read_b64_tr_b16 v[60:61], v7 offset:8192
    s_waitcnt lgkmcnt(13)
    v_mfma_f32_16x16x32_bf16 v[108:111], v[28:31], v[48:51], v[108:111]
    ds_read_b64_tr_b16 v[62:63], v7 offset:9216
    ds_read_b64_tr_b16 v[64:65], v8 offset:8192
    v_mfma_f32_16x16x32_bf16 v[112:115], v[28:31], v[52:55], v[112:115]
    ds_read_b64_tr_b16 v[66:67], v8 offset:9216
    s_waitcnt lgkmcnt(14)
    v_mfma_f32_16x16x32_bf16 v[116:119], v[32:35], v[48:51], v[116:119]
    ds_read_b64_tr_b16 v[68:69], v9 offset:8192
    v_mfma_f32_16x16x32_bf16 v[120:123], v[32:35], v[52:55], v[120:123]
    ds_read_b64_tr_b16 v[70:71], v9 offset:9216
    s_waitcnt lgkmcnt(14)
    v_mfma_f32_16x16x32_bf16 v[124:127], v[36:39], v[48:51], v[124:127]
    ds_read_b64_tr_b16 v[72:73], v10 offset:8192
    ds_read_b64_tr_b16 v[74:75], v10 offset:9216
    v_mfma_f32_16x16x32_bf16 v[128:131], v[36:39], v[52:55], v[128:131]
    ds_read_b64_tr_b16 v[76:77], v11 offset:8192
    s_waitcnt lgkmcnt(15)
    v_mfma_f32_16x16x32_bf16 v[132:135], v[40:43], v[48:51], v[132:135]
    ds_read_b64_tr_b16 v[78:79], v11 offset:9216
    v_mfma_f32_16x16x32_bf16 v[136:139], v[40:43], v[52:55], v[136:139]
    ds_read_b64_tr_b16 v[80:81], v12 offset:8192
    s_waitcnt lgkmcnt(15)
    v_mfma_f32_16x16x32_bf16 v[140:143], v[44:47], v[48:51], v[140:143]
    ds_read_b64_tr_b16 v[82:83], v12 offset:9216
    v_mfma_f32_16x16x32_bf16 v[144:147], v[44:47], v[52:55], v[144:147]
    s_waitcnt lgkmcnt(12)
    v_mfma_f32_16x16x32_bf16 v[92:95], v[56:59], v[84:87], v[92:95]
    v_mfma_f32_16x16x32_bf16 v[96:99], v[56:59], v[88:91], v[96:99]
    s_waitcnt lgkmcnt(10)
    v_mfma_f32_16x16x32_bf16 v[100:103], v[60:63], v[84:87], v[100:103]
    v_mfma_f32_16x16x32_bf16 v[104:107], v[60:63], v[88:91], v[104:107]
    s_waitcnt lgkmcnt(8)
    s_waitcnt lgkmcnt(0)
    s_barrier
    v_mfma_f32_16x16x32_bf16 v[108:111], v[64:67], v[84:87], v[108:111]
    ds_read_b128 v[48:51], v4 offset:16384
    ds_read_b128 v[52:55], v4 offset:18432
    v_mfma_f32_16x16x32_bf16 v[112:115], v[64:67], v[88:91], v[112:115]
    ds_read_b64_tr_b16 v[20:21], v6 offset:16384
    ds_read_b64_tr_b16 v[22:23], v6 offset:17408
    v_mfma_f32_16x16x32_bf16 v[116:119], v[68:71], v[84:87], v[116:119]
    ds_read_b64_tr_b16 v[24:25], v7 offset:16384
    ds_read_b64_tr_b16 v[26:27], v7 offset:17408
    v_mfma_f32_16x16x32_bf16 v[120:123], v[68:71], v[88:91], v[120:123]
    ds_read_b64_tr_b16 v[28:29], v8 offset:16384
    ds_read_b64_tr_b16 v[30:31], v8 offset:17408
    v_mfma_f32_16x16x32_bf16 v[124:127], v[72:75], v[84:87], v[124:127]
    ds_read_b64_tr_b16 v[32:33], v9 offset:16384
    v_mfma_f32_16x16x32_bf16 v[128:131], v[72:75], v[88:91], v[128:131]
    ds_read_b64_tr_b16 v[34:35], v9 offset:17408
    ds_read_b64_tr_b16 v[36:37], v10 offset:16384
    v_mfma_f32_16x16x32_bf16 v[132:135], v[76:79], v[84:87], v[132:135]
    ds_read_b64_tr_b16 v[38:39], v10 offset:17408
    ds_read_b64_tr_b16 v[40:41], v11 offset:16384
    v_mfma_f32_16x16x32_bf16 v[136:139], v[76:79], v[88:91], v[136:139]
    ds_read_b64_tr_b16 v[42:43], v11 offset:17408
    ds_read_b64_tr_b16 v[44:45], v12 offset:16384
    v_mfma_f32_16x16x32_bf16 v[140:143], v[80:83], v[84:87], v[140:143]
    ds_read_b64_tr_b16 v[46:47], v12 offset:17408
    v_mfma_f32_16x16x32_bf16 v[144:147], v[80:83], v[88:91], v[144:147]
    s_waitcnt lgkmcnt(12)
    v_mfma_f32_16x16x32_bf16 v[92:95], v[20:23], v[48:51], v[92:95]
    ds_read_b128 v[84:87], v5 offset:16384
    ds_read_b128 v[88:91], v5 offset:18432
    v_mfma_f32_16x16x32_bf16 v[96:99], v[20:23], v[52:55], v[96:99]
    ds_read_b64_tr_b16 v[56:57], v6 offset:24576
    s_waitcnt lgkmcnt(13)
    v_mfma_f32_16x16x32_bf16 v[100:103], v[24:27], v[48:51], v[100:103]
    ds_read_b64_tr_b16 v[58:59], v6 offset:25600
    v_mfma_f32_16x16x32_bf16 v[104:107], v[24:27], v[52:55], v[104:107]
    ds_read_b64_tr_b16 v[60:61], v7 offset:24576
    s_waitcnt lgkmcnt(13)
    v_mfma_f32_16x16x32_bf16 v[108:111], v[28:31], v[48:51], v[108:111]
    ds_read_b64_tr_b16 v[62:63], v7 offset:25600
    ds_read_b64_tr_b16 v[64:65], v8 offset:24576
    v_mfma_f32_16x16x32_bf16 v[112:115], v[28:31], v[52:55], v[112:115]
    ds_read_b64_tr_b16 v[66:67], v8 offset:25600
    s_waitcnt lgkmcnt(14)
    v_mfma_f32_16x16x32_bf16 v[116:119], v[32:35], v[48:51], v[116:119]
    ds_read_b64_tr_b16 v[68:69], v9 offset:24576
    v_mfma_f32_16x16x32_bf16 v[120:123], v[32:35], v[52:55], v[120:123]
    ds_read_b64_tr_b16 v[70:71], v9 offset:25600
    s_waitcnt lgkmcnt(14)
    v_mfma_f32_16x16x32_bf16 v[124:127], v[36:39], v[48:51], v[124:127]
    ds_read_b64_tr_b16 v[72:73], v10 offset:24576
    ds_read_b64_tr_b16 v[74:75], v10 offset:25600
    v_mfma_f32_16x16x32_bf16 v[128:131], v[36:39], v[52:55], v[128:131]
    ds_read_b64_tr_b16 v[76:77], v11 offset:24576
    s_waitcnt lgkmcnt(15)
    v_mfma_f32_16x16x32_bf16 v[132:135], v[40:43], v[48:51], v[132:135]
    ds_read_b64_tr_b16 v[78:79], v11 offset:25600
    v_mfma_f32_16x16x32_bf16 v[136:139], v[40:43], v[52:55], v[136:139]
    ds_read_b64_tr_b16 v[80:81], v12 offset:24576
    s_waitcnt lgkmcnt(15)
    v_mfma_f32_16x16x32_bf16 v[140:143], v[44:47], v[48:51], v[140:143]
    ds_read_b64_tr_b16 v[82:83], v12 offset:25600
    v_mfma_f32_16x16x32_bf16 v[144:147], v[44:47], v[52:55], v[144:147]
    s_waitcnt lgkmcnt(12)
    v_mfma_f32_16x16x32_bf16 v[92:95], v[56:59], v[84:87], v[92:95]
    v_mfma_f32_16x16x32_bf16 v[96:99], v[56:59], v[88:91], v[96:99]
    s_waitcnt lgkmcnt(10)
    v_mfma_f32_16x16x32_bf16 v[100:103], v[60:63], v[84:87], v[100:103]
    v_mfma_f32_16x16x32_bf16 v[104:107], v[60:63], v[88:91], v[104:107]
    s_waitcnt lgkmcnt(8)
    s_waitcnt lgkmcnt(0)
    s_barrier
    v_mfma_f32_16x16x32_bf16 v[108:111], v[64:67], v[84:87], v[108:111]
    ds_read_b128 v[48:51], v4 offset:32768
    ds_read_b128 v[52:55], v4 offset:34816
    v_mfma_f32_16x16x32_bf16 v[112:115], v[64:67], v[88:91], v[112:115]
    ds_read_b64_tr_b16 v[20:21], v6 offset:32768
    ds_read_b64_tr_b16 v[22:23], v6 offset:33792
    v_mfma_f32_16x16x32_bf16 v[116:119], v[68:71], v[84:87], v[116:119]
    ds_read_b64_tr_b16 v[24:25], v7 offset:32768
    ds_read_b64_tr_b16 v[26:27], v7 offset:33792
    v_mfma_f32_16x16x32_bf16 v[120:123], v[68:71], v[88:91], v[120:123]
    ds_read_b64_tr_b16 v[28:29], v8 offset:32768
    ds_read_b64_tr_b16 v[30:31], v8 offset:33792
    v_mfma_f32_16x16x32_bf16 v[124:127], v[72:75], v[84:87], v[124:127]
    ds_read_b64_tr_b16 v[32:33], v9 offset:32768
    v_mfma_f32_16x16x32_bf16 v[128:131], v[72:75], v[88:91], v[128:131]
    ds_read_b64_tr_b16 v[34:35], v9 offset:33792
    ds_read_b64_tr_b16 v[36:37], v10 offset:32768
    v_mfma_f32_16x16x32_bf16 v[132:135], v[76:79], v[84:87], v[132:135]
    ds_read_b64_tr_b16 v[38:39], v10 offset:33792
    ds_read_b64_tr_b16 v[40:41], v11 offset:32768
    v_mfma_f32_16x16x32_bf16 v[136:139], v[76:79], v[88:91], v[136:139]
    ds_read_b64_tr_b16 v[42:43], v11 offset:33792
    ds_read_b64_tr_b16 v[44:45], v12 offset:32768
    v_mfma_f32_16x16x32_bf16 v[140:143], v[80:83], v[84:87], v[140:143]
    ds_read_b64_tr_b16 v[46:47], v12 offset:33792
    v_mfma_f32_16x16x32_bf16 v[144:147], v[80:83], v[88:91], v[144:147]
    s_waitcnt lgkmcnt(12)
    v_mfma_f32_16x16x32_bf16 v[92:95], v[20:23], v[48:51], v[92:95]
    ds_read_b128 v[84:87], v5 offset:32768
    ds_read_b128 v[88:91], v5 offset:34816
    v_mfma_f32_16x16x32_bf16 v[96:99], v[20:23], v[52:55], v[96:99]
    ds_read_b64_tr_b16 v[56:57], v6 offset:40960
    s_waitcnt lgkmcnt(13)
    v_mfma_f32_16x16x32_bf16 v[100:103], v[24:27], v[48:51], v[100:103]
    ds_read_b64_tr_b16 v[58:59], v6 offset:41984
    v_mfma_f32_16x16x32_bf16 v[104:107], v[24:27], v[52:55], v[104:107]
    ds_read_b64_tr_b16 v[60:61], v7 offset:40960
    s_waitcnt lgkmcnt(13)
    v_mfma_f32_16x16x32_bf16 v[108:111], v[28:31], v[48:51], v[108:111]
    ds_read_b64_tr_b16 v[62:63], v7 offset:41984
    ds_read_b64_tr_b16 v[64:65], v8 offset:40960
    v_mfma_f32_16x16x32_bf16 v[112:115], v[28:31], v[52:55], v[112:115]
    ds_read_b64_tr_b16 v[66:67], v8 offset:41984
    s_waitcnt lgkmcnt(14)
    v_mfma_f32_16x16x32_bf16 v[116:119], v[32:35], v[48:51], v[116:119]
    ds_read_b64_tr_b16 v[68:69], v9 offset:40960
    v_mfma_f32_16x16x32_bf16 v[120:123], v[32:35], v[52:55], v[120:123]
    ds_read_b64_tr_b16 v[70:71], v9 offset:41984
    s_waitcnt lgkmcnt(14)
    v_mfma_f32_16x16x32_bf16 v[124:127], v[36:39], v[48:51], v[124:127]
    ds_read_b64_tr_b16 v[72:73], v10 offset:40960
    ds_read_b64_tr_b16 v[74:75], v10 offset:41984
    v_mfma_f32_16x16x32_bf16 v[128:131], v[36:39], v[52:55], v[128:131]
    ds_read_b64_tr_b16 v[76:77], v11 offset:40960
    s_waitcnt lgkmcnt(15)
    v_mfma_f32_16x16x32_bf16 v[132:135], v[40:43], v[48:51], v[132:135]
    ds_read_b64_tr_b16 v[78:79], v11 offset:41984
    v_mfma_f32_16x16x32_bf16 v[136:139], v[40:43], v[52:55], v[136:139]
    ds_read_b64_tr_b16 v[80:81], v12 offset:40960
    s_waitcnt lgkmcnt(15)
    v_mfma_f32_16x16x32_bf16 v[140:143], v[44:47], v[48:51], v[140:143]
    ds_read_b64_tr_b16 v[82:83], v12 offset:41984
    v_mfma_f32_16x16x32_bf16 v[144:147], v[44:47], v[52:55], v[144:147]
    s_waitcnt lgkmcnt(12)
    v_mfma_f32_16x16x32_bf16 v[92:95], v[56:59], v[84:87], v[92:95]
    ds_read_b128 v[48:51], v4 offset:49152
    ds_read_b128 v[52:55], v4 offset:51200
    v_mfma_f32_16x16x32_bf16 v[96:99], v[56:59], v[88:91], v[96:99]
    ds_read_b64_tr_b16 v[20:21], v6 offset:49152
    s_waitcnt lgkmcnt(13)
    v_mfma_f32_16x16x32_bf16 v[100:103], v[60:63], v[84:87], v[100:103]
    ds_read_b64_tr_b16 v[22:23], v6 offset:50176
    v_mfma_f32_16x16x32_bf16 v[104:107], v[60:63], v[88:91], v[104:107]
    ds_read_b64_tr_b16 v[24:25], v7 offset:49152
    s_waitcnt lgkmcnt(13)
    v_mfma_f32_16x16x32_bf16 v[108:111], v[64:67], v[84:87], v[108:111]
    ds_read_b64_tr_b16 v[26:27], v7 offset:50176
    ds_read_b64_tr_b16 v[28:29], v8 offset:49152
    v_mfma_f32_16x16x32_bf16 v[112:115], v[64:67], v[88:91], v[112:115]
    ds_read_b64_tr_b16 v[30:31], v8 offset:50176
    s_waitcnt lgkmcnt(14)
    v_mfma_f32_16x16x32_bf16 v[116:119], v[68:71], v[84:87], v[116:119]
    ds_read_b64_tr_b16 v[32:33], v9 offset:49152
    v_mfma_f32_16x16x32_bf16 v[120:123], v[68:71], v[88:91], v[120:123]
    ds_read_b64_tr_b16 v[34:35], v9 offset:50176
    s_waitcnt lgkmcnt(14)
    v_mfma_f32_16x16x32_bf16 v[124:127], v[72:75], v[84:87], v[124:127]
    ds_read_b64_tr_b16 v[36:37], v10 offset:49152
    ds_read_b64_tr_b16 v[38:39], v10 offset:50176
    v_mfma_f32_16x16x32_bf16 v[128:131], v[72:75], v[88:91], v[128:131]
    ds_read_b64_tr_b16 v[40:41], v11 offset:49152
    s_waitcnt lgkmcnt(15)
    v_mfma_f32_16x16x32_bf16 v[132:135], v[76:79], v[84:87], v[132:135]
    ds_read_b64_tr_b16 v[42:43], v11 offset:50176
    v_mfma_f32_16x16x32_bf16 v[136:139], v[76:79], v[88:91], v[136:139]
    ds_read_b64_tr_b16 v[44:45], v12 offset:49152
    s_waitcnt lgkmcnt(15)
    v_mfma_f32_16x16x32_bf16 v[140:143], v[80:83], v[84:87], v[140:143]
    ds_read_b64_tr_b16 v[46:47], v12 offset:50176
    v_mfma_f32_16x16x32_bf16 v[144:147], v[80:83], v[88:91], v[144:147]
    s_waitcnt lgkmcnt(12)
    v_mfma_f32_16x16x32_bf16 v[92:95], v[20:23], v[48:51], v[92:95]
    ds_read_b128 v[84:87], v5 offset:49152
    ds_read_b128 v[88:91], v5 offset:51200
    v_mfma_f32_16x16x32_bf16 v[96:99], v[20:23], v[52:55], v[96:99]
    ds_read_b64_tr_b16 v[56:57], v6 offset:57344
    s_waitcnt lgkmcnt(13)
    v_mfma_f32_16x16x32_bf16 v[100:103], v[24:27], v[48:51], v[100:103]
    ds_read_b64_tr_b16 v[58:59], v6 offset:58368
    v_mfma_f32_16x16x32_bf16 v[104:107], v[24:27], v[52:55], v[104:107]
    ds_read_b64_tr_b16 v[60:61], v7 offset:57344
    s_waitcnt lgkmcnt(13)
    v_mfma_f32_16x16x32_bf16 v[108:111], v[28:31], v[48:51], v[108:111]
    ds_read_b64_tr_b16 v[62:63], v7 offset:58368
    ds_read_b64_tr_b16 v[64:65], v8 offset:57344
    v_mfma_f32_16x16x32_bf16 v[112:115], v[28:31], v[52:55], v[112:115]
    ds_read_b64_tr_b16 v[66:67], v8 offset:58368
    s_waitcnt lgkmcnt(14)
    v_mfma_f32_16x16x32_bf16 v[116:119], v[32:35], v[48:51], v[116:119]
    ds_read_b64_tr_b16 v[68:69], v9 offset:57344
    v_mfma_f32_16x16x32_bf16 v[120:123], v[32:35], v[52:55], v[120:123]
    ds_read_b64_tr_b16 v[70:71], v9 offset:58368
    s_waitcnt lgkmcnt(14)
    v_mfma_f32_16x16x32_bf16 v[124:127], v[36:39], v[48:51], v[124:127]
    ds_read_b64_tr_b16 v[72:73], v10 offset:57344
    ds_read_b64_tr_b16 v[74:75], v10 offset:58368
    v_mfma_f32_16x16x32_bf16 v[128:131], v[36:39], v[52:55], v[128:131]
    ds_read_b64_tr_b16 v[76:77], v11 offset:57344
    s_waitcnt lgkmcnt(15)
    v_mfma_f32_16x16x32_bf16 v[132:135], v[40:43], v[48:51], v[132:135]
    ds_read_b64_tr_b16 v[78:79], v11 offset:58368
    v_mfma_f32_16x16x32_bf16 v[136:139], v[40:43], v[52:55], v[136:139]
    ds_read_b64_tr_b16 v[80:81], v12 offset:57344
    s_waitcnt lgkmcnt(15)
    v_mfma_f32_16x16x32_bf16 v[140:143], v[44:47], v[48:51], v[140:143]
    ds_read_b64_tr_b16 v[82:83], v12 offset:58368
    v_mfma_f32_16x16x32_bf16 v[144:147], v[44:47], v[52:55], v[144:147]
    v_and_b32 v16, 15, v1
    s_lshl_b32 s55, s52, 8
    s_add_u32 s55, s55, 159744
    v_lshl_add_u32 v17, v16, 3, s55
    v_lshrrev_b32 v16, 4, v1
    v_lshlrev_b32 v16, 4, v16
    v_add_u32 v16, 162816, v16
    ds_read_b32 v3, v14 offset:96
    s_waitcnt lgkmcnt(13)
    v_mfma_f32_16x16x32_bf16 v[92:95], v[56:59], v[84:87], v[92:95]
    v_mfma_f32_16x16x32_bf16 v[96:99], v[56:59], v[88:91], v[96:99]
    s_waitcnt lgkmcnt(11)
    v_mfma_f32_16x16x32_bf16 v[100:103], v[60:63], v[84:87], v[100:103]
    v_mfma_f32_16x16x32_bf16 v[104:107], v[60:63], v[88:91], v[104:107]
    s_waitcnt lgkmcnt(9)
    s_waitcnt lgkmcnt(0)
    v_readfirstlane_b32 s55, v3
    s_nop 0
    s_cmp_ge_u32 s55, 4
    s_cbranch_scc1 L_CK7
    s_mov_b32 s62, 0x1000000
    s_nop 0
L_CW7:
    ds_read_b32 v3, v14 offset:96
    s_waitcnt lgkmcnt(0)
    v_readfirstlane_b32 s55, v3
    s_sub_u32 s62, s62, 1
    s_cselect_b32 s55, 4, s55
    s_cmp_lt_u32 s55, 4
    s_cbranch_scc1 L_CW7
L_CK7:
    v_mfma_f32_16x16x32_bf16 v[108:111], v[64:67], v[84:87], v[108:111]
    ds_read_b64 v[20:21], v17
    v_mfma_f32_16x16x32_bf16 v[112:115], v[64:67], v[88:91], v[112:115]
    ds_read_b64 v[22:23], v17 offset:128
    v_mfma_f32_16x16x32_bf16 v[116:119], v[68:71], v[84:87], v[116:119]
    ds_read_b128 v[24:27], v16 offset:0
    v_mfma_f32_16x16x32_bf16 v[120:123], v[68:71], v[88:91], v[120:123]
    ds_read_b128 v[28:31], v16 offset:64
    v_mfma_f32_16x16x32_bf16 v[124:127], v[72:75], v[84:87], v[124:127]
    ds_read_b128 v[32:35], v16 offset:128
    v_mfma_f32_16x16x32_bf16 v[128:131], v[72:75], v[88:91], v[128:131]
    ds_read_b128 v[36:39], v16 offset:192
    v_mfma_f32_16x16x32_bf16 v[132:135], v[76:79], v[84:87], v[132:135]
    ds_read_b128 v[40:43], v16 offset:256
    v_mfma_f32_16x16x32_bf16 v[136:139], v[76:79], v[88:91], v[136:139]
    ds_read_b128 v[44:47], v16 offset:320
    v_mfma_f32_16x16x32_bf16 v[140:143], v[80:83], v[84:87], v[140:143]
    ds_read_b128 v[48:51], v16 offset:384
    v_mfma_f32_16x16x32_bf16 v[144:147], v[80:83], v[88:91], v[144:147]
    s_waitcnt lgkmcnt(0)
    s_mov_b64 exec, 1
    ds_add_u32 v14, v15 offset:156
    s_mov_b64 exec, -1
    s_setprio 2
    s_lshl_b32 s55, s53, 3
    s_lshl_b32 s56, s52, 1
    s_add_u32 s55, s55, s56
    s_mul_i32 s55, s55, 56
    s_lshr_b32 s56, s54, 1
    s_mul_i32 s56, s56, 7
    s_add_u32 s55, s55, s56
    s_lshl_b32 s55, s55, 10
    s_lshl_b32 s56, s58, 12
    s_add_u32 s65, s55, s56
    s_add_u32 s66, s65, 57344
    s_lshl_b32 s56, s58, 9
    s_add_u32 s67, s55, s56
    s_add_u32 s67, s67, 3072
    v_and_b32 v16, 15, v1
    v_lshlrev_b32 v16, 4, v16
    v_lshrrev_b32 v18, 5, v1
    v_lshl_add_u32 v16, v18, 8, v16
    v_bfe_u32 v18, v1, 4, 1
    v_lshl_add_u32 v17, v18, 9, v16
    v_mul_u32_u24 v18, 57344, v18
    v_add_u32 v18, v18, v16
    s_mov_b32 s30, 0xbfb8aa3b
    s_mov_b32 s31, 0xbfb8aa3b
    v_mov_b32 v2, 0xbfb8aa3b
    v_mov_b32 v3, 0xbfb8aa3b
    s_waitcnt lgkmcnt(0)
    v_pk_mul_f32 v[56:57], v[24:25], v[20:21] op_sel:[0,1] op_sel_hi:[1,1]
    v_pk_mul_f32 v[58:59], v[26:27], v[20:21] op_sel:[0,1] op_sel_hi:[1,1]
    v_pk_mul_f32 v[60:61], v[28:29], v[20:21] op_sel:[0,1] op_sel_hi:[1,1]
    v_pk_mul_f32 v[62:63], v[30:31], v[20:21] op_sel:[0,1] op_sel_hi:[1,1]
    v_pk_fma_f32 v[56:57], v[92:93], v[20:21], v[56:57] op_sel:[0,0,0] op_sel_hi:[1,0,1]
    v_pk_fma_f32 v[58:59], v[94:95], v[20:21], v[58:59] op_sel:[0,0,0] op_sel_hi:[1,0,1]
    v_pk_fma_f32 v[60:61], v[100:101], v[20:21], v[60:61] op_sel:[0,0,0] op_sel_hi:[1,0,1]
    v_pk_fma_f32 v[62:63], v[102:103], v[20:21], v[62:63] op_sel:[0,0,0] op_sel_hi:[1,0,1]
    v_exp_f32 v64, v56
    v_exp_f32 v65, v57
    v_exp_f32 v66, v58
    v_exp_f32 v67, v59
    v_exp_f32 v68, v60
    v_exp_f32 v69, v61
    v_exp_f32 v70, v62
    v_exp_f32 v71, v63
    v_pk_fma_f32 v[64:65], v[64:65], s[30:31], v[2:3]
    v_pk_fma_f32 v[66:67], v[66:67], s[30:31], v[2:3]
    v_pk_fma_f32 v[68:69], v[68:69], s[30:31], v[2:3]
    v_pk_fma_f32 v[70:71], v[70:71], s[30:31], v[2:3]
    v_rcp_f32 v64, v64
    v_rcp_f32 v65, v65
    v_rcp_f32 v66, v66
    v_rcp_f32 v67, v67
    v_rcp_f32 v68, v68
    v_rcp_f32 v69, v69
    v_rcp_f32 v70, v70
    v_rcp_f32 v71, v71
    v_pk_mul_f32 v[56:57], v[56:57], v[64:65]
    v_pk_mul_f32 v[58:59], v[58:59], v[66:67]
    v_pk_mul_f32 v[60:61], v[60:61], v[68:69]
    v_pk_mul_f32 v[62:63], v[62:63], v[70:71]
    v_cvt_pk_bf16_f32 v148, v56, v57
    v_cvt_pk_bf16_f32 v149, v58, v59
    v_cvt_pk_bf16_f32 v150, v60, v61
    v_cvt_pk_bf16_f32 v151, v62, v63
    v_pk_mul_f32 v[72:73], v[32:33], v[20:21] op_sel:[0,1] op_sel_hi:[1,1]
    v_pk_mul_f32 v[74:75], v[34:35], v[20:21] op_sel:[0,1] op_sel_hi:[1,1]
    v_permlane16_swap_b32 v148, v150
    v_permlane16_swap_b32 v149, v151
    buffer_store_dwordx4 v[148:151], v17, s[12:15], s65 offen offset:0 sc1
    v_pk_mul_f32 v[76:77], v[36:37], v[20:21] op_sel:[0,1] op_sel_hi:[1,1]
    v_pk_mul_f32 v[78:79], v[38:39], v[20:21] op_sel:[0,1] op_sel_hi:[1,1]
    v_pk_fma_f32 v[72:73], v[108:109], v[20:21], v[72:73] op_sel:[0,0,0] op_sel_hi:[1,0,1]
    v_pk_fma_f32 v[74:75], v[110:111], v[20:21], v[74:75] op_sel:[0,0,0] op_sel_hi:[1,0,1]
    v_pk_fma_f32 v[76:77], v[116:117], v[20:21], v[76:77] op_sel:[0,0,0] op_sel_hi:[1,0,1]
    v_pk_fma_f32 v[78:79], v[118:119], v[20:21], v[78:79] op_sel:[0,0,0] op_sel_hi:[1,0,1]
    v_exp_f32 v80, v72
    v_exp_f32 v81, v73
    v_exp_f32 v82, v74
    v_exp_f32 v83, v75
    v_exp_f32 v84, v76
    v_exp_f32 v85, v77
    v_exp_f32 v86, v78
    v_exp_f32 v87, v79
    v_pk_fma_f32 v[80:81], v[80:81], s[30:31], v[2:3]
    v_pk_fma_f32 v[82:83], v[82:83], s[30:31], v[2:3]
    v_pk_fma_f32 v[84:85], v[84:85], s[30:31], v[2:3]
    v_pk_fma_f32 v[86:87], v[86:87], s[30:31], v[2:3]
    v_rcp_f32 v80, v80
    v_rcp_f32 v81, v81
    v_rcp_f32 v82, v82
    v_rcp_f32 v83, v83
    v_rcp_f32 v84, v84
    v_rcp_f32 v85, v85
    v_rcp_f32 v86, v86
    v_rcp_f32 v87, v87
    v_pk_mul_f32 v[72:73], v[72:73], v[80:81]
    v_pk_mul_f32 v[74:75], v[74:75], v[82:83]
    v_pk_mul_f32 v[76:77], v[76:77], v[84:85]
    v_pk_mul_f32 v[78:79], v[78:79], v[86:87]
    v_cvt_pk_bf16_f32 v152, v72, v73
    v_cvt_pk_bf16_f32 v153, v74, v75
    v_cvt_pk_bf16_f32 v154, v76, v77
    v_cvt_pk_bf16_f32 v155, v78, v79
    v_pk_mul_f32 v[56:57], v[40:41], v[20:21] op_sel:[0,1] op_sel_hi:[1,1]
    v_pk_mul_f32 v[58:59], v[42:43], v[20:21] op_sel:[0,1] op_sel_hi:[1,1]
    v_permlane16_swap_b32 v152, v154
    v_permlane16_swap_b32 v153, v155
    buffer_store_dwordx4 v[152:155], v17, s[12:15], s65 offen offset:1024 sc1
    v_pk_mul_f32 v[60:61], v[44:45], v[20:21] op_sel:[0,1] op_sel_hi:[1,1]
    v_pk_mul_f32 v[62:63], v[46:47], v[20:21] op_sel:[0,1] op_sel_hi:[1,1]
    v_pk_fma_f32 v[56:57], v[124:125], v[20:21], v[56:57] op_sel:[0,0,0] op_sel_hi:[1,0,1]
    v_pk_fma_f32 v[58:59], v[126:127], v[20:21], v[58:59] op_sel:[0,0,0] op_sel_hi:[1,0,1]
    v_pk_fma_f32 v[60:61], v[132:133], v[20:21], v[60:61] op_sel:[0,0,0] op_sel_hi:[1,0,1]
    v_pk_fma_f32 v[62:63], v[134:135], v[20:21], v[62:63] op_sel:[0,0,0] op_sel_hi:[1,0,1]
    v_exp_f32 v64, v56
    v_exp_f32 v65, v57
    v_exp_f32 v66, v58
    v_exp_f32 v67, v59
    v_exp_f32 v68, v60
    v_exp_f32 v69, v61
    v_exp_f32 v70, v62
    v_exp_f32 v71, v63
    v_pk_fma_f32 v[64:65], v[64:65], s[30:31], v[2:3]
    v_pk_fma_f32 v[66:67], v[66:67], s[30:31], v[2:3]
    v_pk_fma_f32 v[68:69], v[68:69], s[30:31], v[2:3]
    v_pk_fma_f32 v[70:71], v[70:71], s[30:31], v[2:3]
    v_rcp_f32 v64, v64
    v_rcp_f32 v65, v65
    v_rcp_f32 v66, v66
    v_rcp_f32 v67, v67
    v_rcp_f32 v68, v68
    v_rcp_f32 v69, v69
    v_rcp_f32 v70, v70
    v_rcp_f32 v71, v71
    v_pk_mul_f32 v[56:57], v[56:57], v[64:65]
    v_pk_mul_f32 v[58:59], v[58:59], v[66:67]
    v_pk_mul_f32 v[60:61], v[60:61], v[68:69]
    v_pk_mul_f32 v[62:63], v[62:63], v[70:71]
    v_cvt_pk_bf16_f32 v148, v56, v57
    v_cvt_pk_bf16_f32 v149, v58, v59
    v_cvt_pk_bf16_f32 v150, v60, v61
    v_cvt_pk_bf16_f32 v151, v62, v63
    v_pk_mul_f32 v[72:73], v[24:25], v[22:23] op_sel:[0,1] op_sel_hi:[1,1]
    v_pk_mul_f32 v[74:75], v[26:27], v[22:23] op_sel:[0,1] op_sel_hi:[1,1]
    v_permlane16_swap_b32 v148, v150
    v_permlane16_swap_b32 v149, v151
    buffer_store_dwordx4 v[148:151], v17, s[12:15], s65 offen offset:2048 sc1
    v_pk_mul_f32 v[76:77], v[28:29], v[22:23] op_sel:[0,1] op_sel_hi:[1,1]
    v_pk_mul_f32 v[78:79], v[30:31], v[22:23] op_sel:[0,1] op_sel_hi:[1,1]
    v_pk_fma_f32 v[72:73], v[96:97], v[22:23], v[72:73] op_sel:[0,0,0] op_sel_hi:[1,0,1]
    v_pk_fma_f32 v[74:75], v[98:99], v[22:23], v[74:75] op_sel:[0,0,0] op_sel_hi:[1,0,1]
    v_pk_fma_f32 v[76:77], v[104:105], v[22:23], v[76:77] op_sel:[0,0,0] op_sel_hi:[1,0,1]
    v_pk_fma_f32 v[78:79], v[106:107], v[22:23], v[78:79] op_sel:[0,0,0] op_sel_hi:[1,0,1]
    v_exp_f32 v80, v72
    v_exp_f32 v81, v73
    v_exp_f32 v82, v74
    v_exp_f32 v83, v75
    v_exp_f32 v84, v76
    v_exp_f32 v85, v77
    v_exp_f32 v86, v78
    v_exp_f32 v87, v79
    v_pk_fma_f32 v[80:81], v[80:81], s[30:31], v[2:3]
    v_pk_fma_f32 v[82:83], v[82:83], s[30:31], v[2:3]
    v_pk_fma_f32 v[84:85], v[84:85], s[30:31], v[2:3]
    v_pk_fma_f32 v[86:87], v[86:87], s[30:31], v[2:3]
    v_rcp_f32 v80, v80
    v_rcp_f32 v81, v81
    v_rcp_f32 v82, v82
    v_rcp_f32 v83, v83
    v_rcp_f32 v84, v84
    v_rcp_f32 v85, v85
    v_rcp_f32 v86, v86
    v_rcp_f32 v87, v87
    v_pk_mul_f32 v[72:73], v[72:73], v[80:81]
    v_pk_mul_f32 v[74:75], v[74:75], v[82:83]
    v_pk_mul_f32 v[76:77], v[76:77], v[84:85]
    v_pk_mul_f32 v[78:79], v[78:79], v[86:87]
    v_cvt_pk_bf16_f32 v152, v72, v73
    v_cvt_pk_bf16_f32 v153, v74, v75
    v_cvt_pk_bf16_f32 v154, v76, v77
    v_cvt_pk_bf16_f32 v155, v78, v79
    v_pk_mul_f32 v[56:57], v[32:33], v[22:23] op_sel:[0,1] op_sel_hi:[1,1]
    v_pk_mul_f32 v[58:59], v[34:35], v[22:23] op_sel:[0,1] op_sel_hi:[1,1]
    v_permlane16_swap_b32 v152, v154
    v_permlane16_swap_b32 v153, v155
    buffer_store_dwordx4 v[152:155], v17, s[12:15], s66 offen offset:0 sc1
    v_pk_mul_f32 v[60:61], v[36:37], v[22:23] op_sel:[0,1] op_sel_hi:[1,1]
    v_pk_mul_f32 v[62:63], v[38:39], v[22:23] op_sel:[0,1] op_sel_hi:[1,1]
    v_pk_fma_f32 v[56:57], v[112:113], v[22:23], v[56:57] op_sel:[0,0,0] op_sel_hi:[1,0,1]
    v_pk_fma_f32 v[58:59], v[114:115], v[22:23], v[58:59] op_sel:[0,0,0] op_sel_hi:[1,0,1]
    v_pk_fma_f32 v[60:61], v[120:121], v[22:23], v[60:61] op_sel:[0,0,0] op_sel_hi:[1,0,1]
    v_pk_fma_f32 v[62:63], v[122:123], v[22:23], v[62:63] op_sel:[0,0,0] op_sel_hi:[1,0,1]
    v_exp_f32 v64, v56
    v_exp_f32 v65, v57
    v_exp_f32 v66, v58
    v_exp_f32 v67, v59
    v_exp_f32 v68, v60
    v_exp_f32 v69, v61
    v_exp_f32 v70, v62
    v_exp_f32 v71, v63
    v_pk_fma_f32 v[64:65], v[64:65], s[30:31], v[2:3]
    v_pk_fma_f32 v[66:67], v[66:67], s[30:31], v[2:3]
    v_pk_fma_f32 v[68:69], v[68:69], s[30:31], v[2:3]
    v_pk_fma_f32 v[70:71], v[70:71], s[30:31], v[2:3]
    v_rcp_f32 v64, v64
    v_rcp_f32 v65, v65
    v_rcp_f32 v66, v66
    v_rcp_f32 v67, v67
    v_rcp_f32 v68, v68
    v_rcp_f32 v69, v69
    v_rcp_f32 v70, v70
    v_rcp_f32 v71, v71
    v_pk_mul_f32 v[56:57], v[56:57], v[64:65]
    v_pk_mul_f32 v[58:59], v[58:59], v[66:67]
    v_pk_mul_f32 v[60:61], v[60:61], v[68:69]
    v_pk_mul_f32 v[62:63], v[62:63], v[70:71]
    v_cvt_pk_bf16_f32 v148, v56, v57
    v_cvt_pk_bf16_f32 v149, v58, v59
    v_cvt_pk_bf16_f32 v150, v60, v61
    v_cvt_pk_bf16_f32 v151, v62, v63
    v_pk_mul_f32 v[72:73], v[40:41], v[22:23] op_sel:[0,1] op_sel_hi:[1,1]
    v_pk_mul_f32 v[74:75], v[42:43], v[22:23] op_sel:[0,1] op_sel_hi:[1,1]
    v_permlane16_swap_b32 v148, v150
    v_permlane16_swap_b32 v149, v151
    buffer_store_dwordx4 v[148:151], v17, s[12:15], s66 offen offset:1024 sc1
    v_pk_mul_f32 v[76:77], v[44:45], v[22:23] op_sel:[0,1] op_sel_hi:[1,1]
    v_pk_mul_f32 v[78:79], v[46:47], v[22:23] op_sel:[0,1] op_sel_hi:[1,1]
    v_pk_fma_f32 v[72:73], v[128:129], v[22:23], v[72:73] op_sel:[0,0,0] op_sel_hi:[1,0,1]
    v_pk_fma_f32 v[74:75], v[130:131], v[22:23], v[74:75] op_sel:[0,0,0] op_sel_hi:[1,0,1]
    v_pk_fma_f32 v[76:77], v[136:137], v[22:23], v[76:77] op_sel:[0,0,0] op_sel_hi:[1,0,1]
    v_pk_fma_f32 v[78:79], v[138:139], v[22:23], v[78:79] op_sel:[0,0,0] op_sel_hi:[1,0,1]
    v_exp_f32 v80, v72
    v_exp_f32 v81, v73
    v_exp_f32 v82, v74
    v_exp_f32 v83, v75
    v_exp_f32 v84, v76
    v_exp_f32 v85, v77
    v_exp_f32 v86, v78
    v_exp_f32 v87, v79
    v_pk_fma_f32 v[80:81], v[80:81], s[30:31], v[2:3]
    v_pk_fma_f32 v[82:83], v[82:83], s[30:31], v[2:3]
    v_pk_fma_f32 v[84:85], v[84:85], s[30:31], v[2:3]
    v_pk_fma_f32 v[86:87], v[86:87], s[30:31], v[2:3]
    v_rcp_f32 v80, v80
    v_rcp_f32 v81, v81
    v_rcp_f32 v82, v82
    v_rcp_f32 v83, v83
    v_rcp_f32 v84, v84
    v_rcp_f32 v85, v85
    v_rcp_f32 v86, v86
    v_rcp_f32 v87, v87
    v_pk_mul_f32 v[72:73], v[72:73], v[80:81]
    v_pk_mul_f32 v[74:75], v[74:75], v[82:83]
    v_pk_mul_f32 v[76:77], v[76:77], v[84:85]
    v_pk_mul_f32 v[78:79], v[78:79], v[86:87]
    v_cvt_pk_bf16_f32 v152, v72, v73
    v_cvt_pk_bf16_f32 v153, v74, v75
    v_cvt_pk_bf16_f32 v154, v76, v77
    v_cvt_pk_bf16_f32 v155, v78, v79
    v_pk_mul_f32 v[56:57], v[48:49], v[20:21] op_sel:[0,1] op_sel_hi:[1,1]
    v_pk_mul_f32 v[58:59], v[50:51], v[20:21] op_sel:[0,1] op_sel_hi:[1,1]
    v_permlane16_swap_b32 v152, v154
    v_permlane16_swap_b32 v153, v155
    buffer_store_dwordx4 v[152:155], v17, s[12:15], s66 offen offset:2048 sc1
    v_pk_mul_f32 v[60:61], v[48:49], v[22:23] op_sel:[0,1] op_sel_hi:[1,1]
    v_pk_mul_f32 v[62:63], v[50:51], v[22:23] op_sel:[0,1] op_sel_hi:[1,1]
    v_pk_fma_f32 v[56:57], v[140:141], v[20:21], v[56:57] op_sel:[0,0,0] op_sel_hi:[1,0,1]
    v_pk_fma_f32 v[58:59], v[142:143], v[20:21], v[58:59] op_sel:[0,0,0] op_sel_hi:[1,0,1]
    v_pk_fma_f32 v[60:61], v[144:145], v[22:23], v[60:61] op_sel:[0,0,0] op_sel_hi:[1,0,1]
    v_pk_fma_f32 v[62:63], v[146:147], v[22:23], v[62:63] op_sel:[0,0,0] op_sel_hi:[1,0,1]
    v_exp_f32 v64, v56
    v_exp_f32 v65, v57
    v_exp_f32 v66, v58
    v_exp_f32 v67, v59
    v_exp_f32 v68, v60
    v_exp_f32 v69, v61
    v_exp_f32 v70, v62
    v_exp_f32 v71, v63
    v_pk_fma_f32 v[64:65], v[64:65], s[30:31], v[2:3]
    v_pk_fma_f32 v[66:67], v[66:67], s[30:31], v[2:3]
    v_pk_fma_f32 v[68:69], v[68:69], s[30:31], v[2:3]
    v_pk_fma_f32 v[70:71], v[70:71], s[30:31], v[2:3]
    v_rcp_f32 v64, v64
    v_rcp_f32 v65, v65
    v_rcp_f32 v66, v66
    v_rcp_f32 v67, v67
    v_rcp_f32 v68, v68
    v_rcp_f32 v69, v69
    v_rcp_f32 v70, v70
    v_rcp_f32 v71, v71
    v_pk_mul_f32 v[56:57], v[56:57], v[64:65]
    v_pk_mul_f32 v[58:59], v[58:59], v[66:67]
    v_pk_mul_f32 v[60:61], v[60:61], v[68:69]
    v_pk_mul_f32 v[62:63], v[62:63], v[70:71]
    v_cvt_pk_bf16_f32 v148, v56, v57
    v_cvt_pk_bf16_f32 v149, v58, v59
    v_cvt_pk_bf16_f32 v150, v60, v61
    v_cvt_pk_bf16_f32 v151, v62, v63
    s_nop 0
    v_permlane16_swap_b32 v148, v150
    v_permlane16_swap_b32 v149, v151
    buffer_store_dwordx4 v[148:151], v18, s[12:15], s67 offen sc1
    s_mov_b64 exec, 1
    ds_add_u32 v14, v15 offset:68
    s_mov_b64 exec, -1
    s_lshr_b32 s65, s52, 1
    s_and_b32 s66, s52, 1
    s_mul_i32 s67, s65, 4608
    s_add_u32 s67, s67, 147968
    s_mul_i32 s69, s65, 16640
    s_add_u32 s69, s69, 114688
    v_lshlrev_b32 v13, 4, v1
    v_mov_b32 v6, 163328
    v_mov_b32 v7, 1
    s_lshl_b32 s55, s65, 2
    v_add_u32 v16, s55, v6
    v_and_b32 v17, 3, v1
    v_sub_u32 v17, 3, v17
    v_mul_u32_u24 v17, 4160, v17
    v_bfe_u32 v18, v1, 2, 2
    v_lshrrev_b32 v19, 4, v1
    v_lshlrev_b32 v4, 1, v19
    v_sub_u32 v4, v4, v18
    v_lshl_add_u32 v4, v4, 3, v17
    s_lshl_b32 s55, s66, 8
    s_sub_u32 s56, s69, s55
    s_add_u32 s56, s56, 280
    v_add_u32 v4, s56, v4
    v_and_b32 v17, 15, v1
    v_lshlrev_b32 v17, 5, v17
    v_lshl_add_u32 v5, v19, 4, v17
    s_sub_u32 s56, s67, s55
    s_add_u32 s56, s56, 256
    v_add_u32 v5, s56, v5
    ds_read_b32 v19, v6 offset:0
    s_mov_b32 s58, 0
    s_waitcnt lgkmcnt(0)
    v_readfirstlane_b32 s55, v19
    s_nop 0
    s_cmp_ge_u32 s55, 4
    s_nop 2
    s_cbranch_scc1 L_UR
    s_lshl_b32 s56, s53, 8
    s_lshr_b32 s55, s52, 1
    s_lshl_b32 s55, s55, 7
    s_add_u32 s56, s56, s55
    s_lshl_b32 s55, s54, 3
    s_add_u32 s56, s56, s55
    s_and_b32 s55, s52, 1
    s_lshl_b32 s55, s55, 2
    s_add_u32 s56, s56, s55
    s_add_u32 s56, s56, 13651968
    v_mov_b32 v17, 0
    v_mov_b32 v18, s61
    s_waitcnt vmcnt(0)
    s_setprio 3
    s_mov_b64 exec, 1
    buffer_store_dword v18, v17, s[12:15], s56 offen sc1
    s_mov_b64 exec, -1
    s_mov_b32 s58, 1
    s_mov_b32 s62, 0x1000000
    s_branch L_WU_R
L_WU:
    s_sleep 1
L_WU_R:
    ds_read_b32 v19, v6 offset:0
    s_waitcnt lgkmcnt(0)
    v_readfirstlane_b32 s55, v19
    s_sub_u32 s62, s62, 1
    s_cselect_b32 s55, 4, s55
    s_cmp_lt_u32 s55, 4
    s_cbranch_scc1 L_WU
    s_nop 0
L_UR:
    s_or_b32 s55, s2, s52
    s_cmp_lg_u32 s55, 0
    s_cbranch_scc1 L_NOEP
    s_mov_b32 s55, 13657088
    v_mov_b32 v17, 0
    v_mov_b32 v18, s61
    s_mov_b64 exec, 1
    buffer_store_dword v18, v17, s[12:15], s55 offen sc1
    s_mov_b64 exec, -1
L_NOEP:
    s_setprio 0
    ds_read_b128 v[84:87], v5 offset:192
    ds_read_b64 v[52:53], v4 offset:3776
    ds_read_b64 v[54:55], v4 offset:3784
    ds_read_b128 v[88:91], v5 offset:704
    ds_read_b64 v[56:57], v4 offset:3264
    ds_read_b64 v[58:59], v4 offset:3272
    ds_read_b128 v[92:95], v5 offset:1216
    ds_read_b64 v[60:61], v4 offset:2752
    ds_read_b64 v[62:63], v4 offset:2760
    ds_read_b128 v[96:99], v5 offset:1728
    ds_read_b64 v[64:65], v4 offset:2240
    ds_read_b64 v[66:67], v4 offset:2248
    ds_read_b128 v[100:103], v5 offset:2240
    ds_read_b64 v[68:69], v4 offset:1728
    ds_read_b64 v[70:71], v4 offset:1736
    ds_read_b128 v[104:107], v5 offset:2752
    ds_read_b64 v[72:73], v4 offset:1216
    ds_read_b64 v[74:75], v4 offset:1224
    ds_read_b128 v[108:111], v5 offset:3264
    ds_read_b64 v[76:77], v4 offset:704
    ds_read_b64 v[78:79], v4 offset:712
    ds_read_b128 v[112:115], v5 offset:3776
    ds_read_b64 v[80:81], v4 offset:192
    ds_read_b64 v[82:83], v4 offset:200
    s_waitcnt lgkmcnt(0)
    v_mfma_f32_16x16x32_f16 v[20:23], v[52:55], v[84:87], 0
    ds_read_b128 v[148:151], v5 offset:128
    v_mfma_f32_16x16x32_f16 v[24:27], v[52:55], v[88:91], 0
    ds_read_b64 v[116:117], v4 offset:3712
    v_mfma_f32_16x16x32_f16 v[28:31], v[52:55], v[92:95], 0
    ds_read_b64 v[118:119], v4 offset:3720
    v_mfma_f32_16x16x32_f16 v[32:35], v[52:55], v[96:99], 0
    ds_read_b128 v[152:155], v5 offset:640
    v_mfma_f32_16x16x32_f16 v[36:39], v[52:55], v[100:103], 0
    ds_read_b64 v[120:121], v4 offset:3200
    v_mfma_f32_16x16x32_f16 v[40:43], v[52:55], v[104:107], 0
    ds_read_b64 v[122:123], v4 offset:3208
    v_mfma_f32_16x16x32_f16 v[44:47], v[52:55], v[108:111], 0
    ds_read_b128 v[156:159], v5 offset:1152
    v_mfma_f32_16x16x32_f16 v[48:51], v[52:55], v[112:115], 0
    ds_read_b64 v[124:125], v4 offset:2688
    v_mfma_f32_16x16x32_f16 v[24:27], v[56:59], v[84:87], v[24:27]
    ds_read_b64 v[126:127], v4 offset:2696
    v_mfma_f32_16x16x32_f16 v[28:31], v[56:59], v[88:91], v[28:31]
    ds_read_b128 v[160:163], v5 offset:1664
    v_mfma_f32_16x16x32_f16 v[32:35], v[56:59], v[92:95], v[32:35]
    ds_read_b64 v[128:129], v4 offset:2176
    v_mfma_f32_16x16x32_f16 v[36:39], v[56:59], v[96:99], v[36:39]
    ds_read_b64 v[130:131], v4 offset:2184
    v_mfma_f32_16x16x32_f16 v[40:43], v[56:59], v[100:103], v[40:43]
    ds_read_b128 v[164:167], v5 offset:2176
    v_mfma_f32_16x16x32_f16 v[44:47], v[56:59], v[104:107], v[44:47]
    ds_read_b64 v[132:133], v4 offset:1664
    v_mfma_f32_16x16x32_f16 v[48:51], v[56:59], v[108:111], v[48:51]
    ds_read_b64 v[134:135], v4 offset:1672
    v_mfma_f32_16x16x32_f16 v[28:31], v[60:63], v[84:87], v[28:31]
    ds_read_b128 v[168:171], v5 offset:2688
    v_mfma_f32_16x16x32_f16 v[32:35], v[60:63], v[88:91], v[32:35]
    ds_read_b64 v[136:137], v4 offset:1152
    v_mfma_f32_16x16x32_f16 v[36:39], v[60:63], v[92:95], v[36:39]
    ds_read_b64 v[138:139], v4 offset:1160
    v_mfma_f32_16x16x32_f16 v[40:43], v[60:63], v[96:99], v[40:43]
    ds_read_b128 v[172:175], v5 offset:3200
    v_mfma_f32_16x16x32_f16 v[44:47], v[60:63], v[100:103], v[44:47]
    ds_read_b64 v[140:141], v4 offset:640
    v_mfma_f32_16x16x32_f16 v[48:51], v[60:63], v[104:107], v[48:51]
    ds_read_b64 v[142:143], v4 offset:648
    v_mfma_f32_16x16x32_f16 v[32:35], v[64:67], v[84:87], v[32:35]
    ds_read_b128 v[176:179], v5 offset:3712
    v_mfma_f32_16x16x32_f16 v[36:39], v[64:67], v[88:91], v[36:39]
    ds_read_b64 v[144:145], v4 offset:128
    v_mfma_f32_16x16x32_f16 v[40:43], v[64:67], v[92:95], v[40:43]
    ds_read_b64 v[146:147], v4 offset:136
    v_mfma_f32_16x16x32_f16 v[44:47], v[64:67], v[96:99], v[44:47]
    v_mfma_f32_16x16x32_f16 v[48:51], v[64:67], v[100:103], v[48:51]
    v_mfma_f32_16x16x32_f16 v[36:39], v[68:71], v[84:87], v[36:39]
    v_mfma_f32_16x16x32_f16 v[40:43], v[68:71], v[88:91], v[40:43]
    v_mfma_f32_16x16x32_f16 v[44:47], v[68:71], v[92:95], v[44:47]
    v_mfma_f32_16x16x32_f16 v[48:51], v[68:71], v[96:99], v[48:51]
    v_mfma_f32_16x16x32_f16 v[40:43], v[72:75], v[84:87], v[40:43]
    v_mfma_f32_16x16x32_f16 v[44:47], v[72:75], v[88:91], v[44:47]
    v_mfma_f32_16x16x32_f16 v[48:51], v[72:75], v[92:95], v[48:51]
    v_mfma_f32_16x16x32_f16 v[44:47], v[76:79], v[84:87], v[44:47]
    v_mfma_f32_16x16x32_f16 v[48:51], v[76:79], v[88:91], v[48:51]
    v_mfma_f32_16x16x32_f16 v[48:51], v[80:83], v[84:87], v[48:51]
    s_cmp_eq_u32 s58, 1
    s_nop 6
    s_cbranch_scc1 L_F2D
    s_lshl_b32 s56, s53, 8
    s_lshr_b32 s55, s52, 1
    s_lshl_b32 s55, s55, 7
    s_add_u32 s56, s56, s55
    s_lshl_b32 s55, s54, 3
    s_add_u32 s56, s56, s55
    s_and_b32 s55, s52, 1
    s_lshl_b32 s55, s55, 2
    s_add_u32 s56, s56, s55
    s_add_u32 s56, s56, 13651968
    v_mov_b32 v17, 0
    v_mov_b32 v18, s61
    s_waitcnt vmcnt(0)
    s_setprio 3
    s_mov_b64 exec, 1
    buffer_store_dword v18, v17, s[12:15], s56 offen sc1
    s_mov_b64 exec, -1
L_F2D:
    s_setprio 3
    v_lshrrev_b32 v2, 3, v0
    v_and_b32 v3, 7, v0
    v_lshlrev_b32 v3, 4, v3
    v_lshl_add_u32 v12, v2, 10, v3
    s_lshl_b32 s55, s63, 16
    s_lshl_b32 s56, s64, 7
    s_add_u32 s55, s55, s56
    v_add_u32 v12, s55, v12
    buffer_load_dwordx4 v[8:11], v12, s[4:7], 0 offen
    s_setprio 0
    s_waitcnt lgkmcnt(0)
    v_mfma_f32_16x16x32_f16 v[20:23], v[116:119], v[148:151], v[20:23]
    ds_read_b128 v[84:87], v5 offset:64
    v_mfma_f32_16x16x32_f16 v[24:27], v[116:119], v[152:155], v[24:27]
    ds_read_b64 v[52:53], v4 offset:3648
    v_mfma_f32_16x16x32_f16 v[28:31], v[116:119], v[156:159], v[28:31]
    ds_read_b64 v[54:55], v4 offset:3656
    v_mfma_f32_16x16x32_f16 v[32:35], v[116:119], v[160:163], v[32:35]
    ds_read_b128 v[88:91], v5 offset:576
    v_mfma_f32_16x16x32_f16 v[36:39], v[116:119], v[164:167], v[36:39]
    ds_read_b64 v[56:57], v4 offset:3136
    v_mfma_f32_16x16x32_f16 v[40:43], v[116:119], v[168:171], v[40:43]
    ds_read_b64 v[58:59], v4 offset:3144
    v_mfma_f32_16x16x32_f16 v[44:47], v[116:119], v[172:175], v[44:47]
    ds_read_b128 v[92:95], v5 offset:1088
    v_mfma_f32_16x16x32_f16 v[48:51], v[116:119], v[176:179], v[48:51]
    ds_read_b64 v[60:61], v4 offset:2624
    v_mfma_f32_16x16x32_f16 v[24:27], v[120:123], v[148:151], v[24:27]
    ds_read_b64 v[62:63], v4 offset:2632
    v_mfma_f32_16x16x32_f16 v[28:31], v[120:123], v[152:155], v[28:31]
    ds_read_b128 v[96:99], v5 offset:1600
    v_mfma_f32_16x16x32_f16 v[32:35], v[120:123], v[156:159], v[32:35]
    ds_read_b64 v[64:65], v4 offset:2112
    v_mfma_f32_16x16x32_f16 v[36:39], v[120:123], v[160:163], v[36:39]
    ds_read_b64 v[66:67], v4 offset:2120
    v_mfma_f32_16x16x32_f16 v[40:43], v[120:123], v[164:167], v[40:43]
    ds_read_b128 v[100:103], v5 offset:2112
    v_mfma_f32_16x16x32_f16 v[44:47], v[120:123], v[168:171], v[44:47]
    ds_read_b64 v[68:69], v4 offset:1600
    v_mfma_f32_16x16x32_f16 v[48:51], v[120:123], v[172:175], v[48:51]
    ds_read_b64 v[70:71], v4 offset:1608
    v_mfma_f32_16x16x32_f16 v[28:31], v[124:127], v[148:151], v[28:31]
    ds_read_b128 v[104:107], v5 offset:2624
    v_mfma_f32_16x16x32_f16 v[32:35], v[124:127], v[152:155], v[32:35]
    ds_read_b64 v[72:73], v4 offset:1088
    v_mfma_f32_16x16x32_f16 v[36:39], v[124:127], v[156:159], v[36:39]
    ds_read_b64 v[74:75], v4 offset:1096
    v_mfma_f32_16x16x32_f16 v[40:43], v[124:127], v[160:163], v[40:43]
    ds_read_b128 v[108:111], v5 offset:3136
    v_mfma_f32_16x16x32_f16 v[44:47], v[124:127], v[164:167], v[44:47]
    ds_read_b64 v[76:77], v4 offset:576
    v_mfma_f32_16x16x32_f16 v[48:51], v[124:127], v[168:171], v[48:51]
    ds_read_b64 v[78:79], v4 offset:584
    v_mfma_f32_16x16x32_f16 v[32:35], v[128:131], v[148:151], v[32:35]
    ds_read_b128 v[112:115], v5 offset:3648
    v_mfma_f32_16x16x32_f16 v[36:39], v[128:131], v[152:155], v[36:39]
    ds_read_b64 v[80:81], v4 offset:64
    v_mfma_f32_16x16x32_f16 v[40:43], v[128:131], v[156:159], v[40:43]
    ds_read_b64 v[82:83], v4 offset:72
    v_mfma_f32_16x16x32_f16 v[44:47], v[128:131], v[160:163], v[44:47]
    v_mfma_f32_16x16x32_f16 v[48:51], v[128:131], v[164:167], v[48:51]
    v_mfma_f32_16x16x32_f16 v[36:39], v[132:135], v[148:151], v[36:39]
    v_mfma_f32_16x16x32_f16 v[40:43], v[132:135], v[152:155], v[40:43]
    v_mfma_f32_16x16x32_f16 v[44:47], v[132:135], v[156:159], v[44:47]
    v_mfma_f32_16x16x32_f16 v[48:51], v[132:135], v[160:163], v[48:51]
    v_mfma_f32_16x16x32_f16 v[40:43], v[136:139], v[148:151], v[40:43]
    v_mfma_f32_16x16x32_f16 v[44:47], v[136:139], v[152:155], v[44:47]
    v_mfma_f32_16x16x32_f16 v[48:51], v[136:139], v[156:159], v[48:51]
    v_mfma_f32_16x16x32_f16 v[44:47], v[140:143], v[148:151], v[44:47]
    v_mfma_f32_16x16x32_f16 v[48:51], v[140:143], v[152:155], v[48:51]
    v_mfma_f32_16x16x32_f16 v[48:51], v[144:147], v[148:151], v[48:51]
    s_waitcnt lgkmcnt(0)
    v_mfma_f32_16x16x32_f16 v[20:23], v[52:55], v[84:87], v[20:23]
    ds_read_b128 v[148:151], v5 offset:0
    v_mfma_f32_16x16x32_f16 v[24:27], v[52:55], v[88:91], v[24:27]
    ds_read_b64 v[116:117], v4 offset:3584
    v_mfma_f32_16x16x32_f16 v[28:31], v[52:55], v[92:95], v[28:31]
    ds_read_b64 v[118:119], v4 offset:3592
    v_mfma_f32_16x16x32_f16 v[32:35], v[52:55], v[96:99], v[32:35]
    ds_read_b128 v[152:155], v5 offset:512
    v_mfma_f32_16x16x32_f16 v[36:39], v[52:55], v[100:103], v[36:39]
    ds_read_b64 v[120:121], v4 offset:3072
    v_mfma_f32_16x16x32_f16 v[40:43], v[52:55], v[104:107], v[40:43]
    ds_read_b64 v[122:123], v4 offset:3080
    v_mfma_f32_16x16x32_f16 v[44:47], v[52:55], v[108:111], v[44:47]
    ds_read_b128 v[156:159], v5 offset:1024
    v_mfma_f32_16x16x32_f16 v[48:51], v[52:55], v[112:115], v[48:51]
    ds_read_b64 v[124:125], v4 offset:2560
    v_mfma_f32_16x16x32_f16 v[24:27], v[56:59], v[84:87], v[24:27]
    ds_read_b64 v[126:127], v4 offset:2568
    v_mfma_f32_16x16x32_f16 v[28:31], v[56:59], v[88:91], v[28:31]
    ds_read_b128 v[160:163], v5 offset:1536
    v_mfma_f32_16x16x32_f16 v[32:35], v[56:59], v[92:95], v[32:35]
    ds_read_b64 v[128:129], v4 offset:2048
    v_mfma_f32_16x16x32_f16 v[36:39], v[56:59], v[96:99], v[36:39]
    ds_read_b64 v[130:131], v4 offset:2056
    v_mfma_f32_16x16x32_f16 v[40:43], v[56:59], v[100:103], v[40:43]
    ds_read_b128 v[164:167], v5 offset:2048
    v_mfma_f32_16x16x32_f16 v[44:47], v[56:59], v[104:107], v[44:47]
    ds_read_b64 v[132:133], v4 offset:1536
    v_mfma_f32_16x16x32_f16 v[48:51], v[56:59], v[108:111], v[48:51]
    ds_read_b64 v[134:135], v4 offset:1544
    v_mfma_f32_16x16x32_f16 v[28:31], v[60:63], v[84:87], v[28:31]
    ds_read_b128 v[168:171], v5 offset:2560
    v_mfma_f32_16x16x32_f16 v[32:35], v[60:63], v[88:91], v[32:35]
    ds_read_b64 v[136:137], v4 offset:1024
    v_mfma_f32_16x16x32_f16 v[36:39], v[60:63], v[92:95], v[36:39]
    ds_read_b64 v[138:139], v4 offset:1032
    v_mfma_f32_16x16x32_f16 v[40:43], v[60:63], v[96:99], v[40:43]
    ds_read_b128 v[172:175], v5 offset:3072
    v_mfma_f32_16x16x32_f16 v[44:47], v[60:63], v[100:103], v[44:47]
    ds_read_b64 v[140:141], v4 offset:512
    v_mfma_f32_16x16x32_f16 v[48:51], v[60:63], v[104:107], v[48:51]
    ds_read_b64 v[142:143], v4 offset:520
    v_mfma_f32_16x16x32_f16 v[32:35], v[64:67], v[84:87], v[32:35]
    ds_read_b128 v[176:179], v5 offset:3584
    v_mfma_f32_16x16x32_f16 v[36:39], v[64:67], v[88:91], v[36:39]
    ds_read_b64 v[144:145], v4 offset:0
    v_mfma_f32_16x16x32_f16 v[40:43], v[64:67], v[92:95], v[40:43]
    ds_read_b64 v[146:147], v4 offset:8
    v_mfma_f32_16x16x32_f16 v[44:47], v[64:67], v[96:99], v[44:47]
    v_mfma_f32_16x16x32_f16 v[48:51], v[64:67], v[100:103], v[48:51]
    v_mfma_f32_16x16x32_f16 v[36:39], v[68:71], v[84:87], v[36:39]
    v_mfma_f32_16x16x32_f16 v[40:43], v[68:71], v[88:91], v[40:43]
    v_mfma_f32_16x16x32_f16 v[44:47], v[68:71], v[92:95], v[44:47]
    v_mfma_f32_16x16x32_f16 v[48:51], v[68:71], v[96:99], v[48:51]
    v_mfma_f32_16x16x32_f16 v[40:43], v[72:75], v[84:87], v[40:43]
    v_mfma_f32_16x16x32_f16 v[44:47], v[72:75], v[88:91], v[44:47]
    v_mfma_f32_16x16x32_f16 v[48:51], v[72:75], v[92:95], v[48:51]
    v_mfma_f32_16x16x32_f16 v[44:47], v[76:79], v[84:87], v[44:47]
    v_mfma_f32_16x16x32_f16 v[48:51], v[76:79], v[88:91], v[48:51]
    v_mfma_f32_16x16x32_f16 v[48:51], v[80:83], v[84:87], v[48:51]
    s_waitcnt lgkmcnt(0)
    s_mov_b64 exec, 1
    ds_add_u32 v6, v7 offset:16
    s_mov_b64 exec, -1
    v_mfma_f32_16x16x32_f16 v[20:23], v[116:119], v[148:151], v[20:23]
    v_mfma_f32_16x16x32_f16 v[24:27], v[116:119], v[152:155], v[24:27]
    v_mfma_f32_16x16x32_f16 v[28:31], v[116:119], v[156:159], v[28:31]
    v_mfma_f32_16x16x32_f16 v[32:35], v[116:119], v[160:163], v[32:35]
    v_mfma_f32_16x16x32_f16 v[36:39], v[116:119], v[164:167], v[36:39]
    v_mfma_f32_16x16x32_f16 v[40:43], v[116:119], v[168:171], v[40:43]
    v_mfma_f32_16x16x32_f16 v[44:47], v[116:119], v[172:175], v[44:47]
    v_mfma_f32_16x16x32_f16 v[48:51], v[116:119], v[176:179], v[48:51]
    v_mfma_f32_16x16x32_f16 v[24:27], v[120:123], v[148:151], v[24:27]
    v_mfma_f32_16x16x32_f16 v[28:31], v[120:123], v[152:155], v[28:31]
    v_mfma_f32_16x16x32_f16 v[32:35], v[120:123], v[156:159], v[32:35]
    v_mfma_f32_16x16x32_f16 v[36:39], v[120:123], v[160:163], v[36:39]
    v_mfma_f32_16x16x32_f16 v[40:43], v[120:123], v[164:167], v[40:43]
    v_mfma_f32_16x16x32_f16 v[44:47], v[120:123], v[168:171], v[44:47]
    v_mfma_f32_16x16x32_f16 v[48:51], v[120:123], v[172:175], v[48:51]
    v_mfma_f32_16x16x32_f16 v[28:31], v[124:127], v[148:151], v[28:31]
    v_mfma_f32_16x16x32_f16 v[32:35], v[124:127], v[152:155], v[32:35]
    v_mfma_f32_16x16x32_f16 v[36:39], v[124:127], v[156:159], v[36:39]
    v_mfma_f32_16x16x32_f16 v[40:43], v[124:127], v[160:163], v[40:43]
    v_mfma_f32_16x16x32_f16 v[44:47], v[124:127], v[164:167], v[44:47]
    v_mfma_f32_16x16x32_f16 v[48:51], v[124:127], v[168:171], v[48:51]
    v_mfma_f32_16x16x32_f16 v[32:35], v[128:131], v[148:151], v[32:35]
    v_mfma_f32_16x16x32_f16 v[36:39], v[128:131], v[152:155], v[36:39]
    v_mfma_f32_16x16x32_f16 v[40:43], v[128:131], v[156:159], v[40:43]
    v_mfma_f32_16x16x32_f16 v[44:47], v[128:131], v[160:163], v[44:47]
    v_mfma_f32_16x16x32_f16 v[48:51], v[128:131], v[164:167], v[48:51]
    v_mfma_f32_16x16x32_f16 v[36:39], v[132:135], v[148:151], v[36:39]
    v_mfma_f32_16x16x32_f16 v[40:43], v[132:135], v[152:155], v[40:43]
    v_mfma_f32_16x16x32_f16 v[44:47], v[132:135], v[156:159], v[44:47]
    v_mfma_f32_16x16x32_f16 v[48:51], v[132:135], v[160:163], v[48:51]
    v_mfma_f32_16x16x32_f16 v[40:43], v[136:139], v[148:151], v[40:43]
    v_mfma_f32_16x16x32_f16 v[44:47], v[136:139], v[152:155], v[44:47]
    v_mfma_f32_16x16x32_f16 v[48:51], v[136:139], v[156:159], v[48:51]
    v_mfma_f32_16x16x32_f16 v[44:47], v[140:143], v[148:151], v[44:47]
    v_mfma_f32_16x16x32_f16 v[48:51], v[140:143], v[152:155], v[48:51]
    v_mfma_f32_16x16x32_f16 v[48:51], v[144:147], v[148:151], v[48:51]
    s_setprio 2
    s_mov_b32 s62, 0x1000000
    s_nop 5
L_WCV:
    ds_read_b32 v19, v6 offset:16
    s_waitcnt lgkmcnt(0)
    v_readfirstlane_b32 s55, v19
    s_sub_u32 s62, s62, 1
    s_cselect_b32 s55, 4, s55
    s_cmp_lt_u32 s55, 4
    s_cbranch_scc1 L_WCV
    s_lshl_b32 s55, s52, 13
    s_add_u32 s55, s55, 114688
    v_add_u32 v17, s55, v13
    ds_write_b128 v17, v[20:23] offset:0
    ds_write_b128 v17, v[24:27] offset:1024
    ds_write_b128 v17, v[28:31] offset:2048
    ds_write_b128 v17, v[32:35] offset:3072
    ds_write_b128 v17, v[36:39] offset:4096
    ds_write_b128 v17, v[40:43] offset:5120
    ds_write_b128 v17, v[44:47] offset:6144
    ds_write_b128 v17, v[48:51] offset:7168
    s_lshl_b32 s55, s52, 11
    s_add_u32 s56, s55, 114688
    v_add_u32 v16, s56, v13
    v_and_b32 v4, 15, v1
    v_lshrrev_b32 v5, 4, v1
    v_lshlrev_b32 v5, 2, v5
    v_lshl_add_u32 v4, v4, 4, v5
    s_lshl_b32 s56, s52, 10
    s_add_u32 s56, s56, 148448
    v_lshl_add_u32 v5, v4, 1, s56
    v_lshlrev_b32 v4, 2, v4
    s_lshl_b32 s57, s60, 14
    s_add_u32 s57, s57, s55
    s_add_u32 s57, s57, s55
    s_add_u32 s57, s57, 9437184
    s_and_b32 s69, s68, 0xffff0000
    s_lshl_b32 s68, s68, 16
    s_waitcnt lgkmcnt(0)
    ds_read_b64 v[116:117], v5 offset:0
    ds_read_b64 v[118:119], v5 offset:4608
    ds_read_b64 v[120:121], v5 offset:512
    ds_read_b64 v[122:123], v5 offset:5120
    s_mov_b64 exec, 1
    ds_add_u32 v6, v7 offset:20
    s_mov_b64 exec, -1
    ds_read_b64 v[124:125], v6 offset:40
    s_mov_b32 s62, 0x1000000
L_WEX:
    ds_read_b32 v19, v6 offset:20
    s_waitcnt lgkmcnt(0)
    v_readfirstlane_b32 s55, v19
    s_sub_u32 s62, s62, 1
    s_cselect_b32 s55, 4, s55
    s_cmp_lt_u32 s55, 4
    s_cbranch_scc1 L_WEX
    ds_read_b128 v[52:55], v16 offset:0
    ds_read_b128 v[56:59], v16 offset:8192
    ds_read_b128 v[60:63], v16 offset:16384
    ds_read_b128 v[64:67], v16 offset:24576
    ds_read_b128 v[68:71], v16 offset:1024
    ds_read_b128 v[72:75], v16 offset:9216
    ds_read_b128 v[76:79], v16 offset:17408
    ds_read_b128 v[80:83], v16 offset:25600
    s_waitcnt lgkmcnt(4)
    v_add_f32 v52, v52, v56
    v_add_f32 v53, v53, v57
    v_add_f32 v54, v54, v58
    v_add_f32 v55, v55, v59
    v_mul_f32 v52, v124, v52
    v_mul_f32 v53, v124, v53
    v_mul_f32 v54, v124, v54
    v_mul_f32 v55, v124, v55
    v_fma_mix_f32 v52, v116, s68, v52 op_sel:[0,0,0] op_sel_hi:[1,0,0]
    v_fma_mix_f32 v53, v116, s68, v53 op_sel:[1,0,0] op_sel_hi:[1,0,0]
    v_fma_mix_f32 v54, v117, s68, v54 op_sel:[0,0,0] op_sel_hi:[1,0,0]
    v_fma_mix_f32 v55, v117, s68, v55 op_sel:[1,0,0] op_sel_hi:[1,0,0]
    v_add_f32 v60, v60, v64
    v_add_f32 v61, v61, v65
    v_add_f32 v62, v62, v66
    v_add_f32 v63, v63, v67
    v_mul_f32 v60, v125, v60
    v_mul_f32 v61, v125, v61
    v_mul_f32 v62, v125, v62
    v_mul_f32 v63, v125, v63
    v_fma_mix_f32 v60, v118, s69, v60 op_sel:[0,0,0] op_sel_hi:[1,0,0]
    v_fma_mix_f32 v61, v118, s69, v61 op_sel:[1,0,0] op_sel_hi:[1,0,0]
    v_fma_mix_f32 v62, v119, s69, v62 op_sel:[0,0,0] op_sel_hi:[1,0,0]
    v_fma_mix_f32 v63, v119, s69, v63 op_sel:[1,0,0] op_sel_hi:[1,0,0]
    v_cvt_pk_bf16_f32 v128, v52, v60
    v_mov_b32 v129, s61
    v_cvt_pk_bf16_f32 v130, v53, v61
    v_mov_b32 v131, s61
    v_cvt_pk_bf16_f32 v132, v54, v62
    v_mov_b32 v133, s61
    v_cvt_pk_bf16_f32 v134, v55, v63
    v_mov_b32 v135, s61
    buffer_store_dwordx4 v[128:131], v4, s[12:15], s57 offen offset:0 sc1
    buffer_store_dwordx4 v[132:135], v4, s[12:15], s57 offen offset:1024 sc1
    s_waitcnt lgkmcnt(0)
    v_add_f32 v68, v68, v72
    v_add_f32 v69, v69, v73
    v_add_f32 v70, v70, v74
    v_add_f32 v71, v71, v75
    v_mul_f32 v68, v124, v68
    v_mul_f32 v69, v124, v69
    v_mul_f32 v70, v124, v70
    v_mul_f32 v71, v124, v71
    v_fma_mix_f32 v68, v120, s68, v68 op_sel:[0,0,0] op_sel_hi:[1,0,0]
    v_fma_mix_f32 v69, v120, s68, v69 op_sel:[1,0,0] op_sel_hi:[1,0,0]
    v_fma_mix_f32 v70, v121, s68, v70 op_sel:[0,0,0] op_sel_hi:[1,0,0]
    v_fma_mix_f32 v71, v121, s68, v71 op_sel:[1,0,0] op_sel_hi:[1,0,0]
    v_add_f32 v76, v76, v80
    v_add_f32 v77, v77, v81
    v_add_f32 v78, v78, v82
    v_add_f32 v79, v79, v83
    v_mul_f32 v76, v125, v76
    v_mul_f32 v77, v125, v77
    v_mul_f32 v78, v125, v78
    v_mul_f32 v79, v125, v79
    v_fma_mix_f32 v76, v122, s69, v76 op_sel:[0,0,0] op_sel_hi:[1,0,0]
    v_fma_mix_f32 v77, v122, s69, v77 op_sel:[1,0,0] op_sel_hi:[1,0,0]
    v_fma_mix_f32 v78, v123, s69, v78 op_sel:[0,0,0] op_sel_hi:[1,0,0]
    v_fma_mix_f32 v79, v123, s69, v79 op_sel:[1,0,0] op_sel_hi:[1,0,0]
    v_cvt_pk_bf16_f32 v136, v68, v76
    v_mov_b32 v137, s61
    v_cvt_pk_bf16_f32 v138, v69, v77
    v_mov_b32 v139, s61
    v_cvt_pk_bf16_f32 v140, v70, v78
    v_mov_b32 v141, s61
    v_cvt_pk_bf16_f32 v142, v71, v79
    v_mov_b32 v143, s61
    buffer_store_dwordx4 v[136:139], v4, s[12:15], s57 offen offset:2048 sc1
    buffer_store_dwordx4 v[140:143], v4, s[12:15], s57 offen offset:3072 sc1
    v_lshrrev_b32 v4, 5, v1
    v_bfe_u32 v5, v1, 4, 1
    v_and_b32 v19, 15, v1
    v_lshlrev_b32 v18, 4, v19
    v_lshl_add_u32 v18, v5, 10, v18
    v_lshl_add_u32 v18, v4, 14, v18
    s_lshl_b32 s65, s64, 19
    s_lshl_b32 s57, s52, 17
    s_add_u32 s65, s65, s57
    s_lshr_b32 s57, s63, 2
    s_lshl_b32 s57, s57, 11
    s_add_u32 s65, s65, s57
    s_and_b32 s57, s63, 3
    s_lshl_b32 s57, s57, 8
    s_add_u32 s65, s65, s57
    s_add_u32 s65, s65, 9437184
    s_add_u32 s66, s65, 32768
    s_add_u32 s67, s65, 65536
    s_add_u32 s68, s65, 98304
    s_lshl_b32 s57, s52, 3
    v_add_u32 v4, s57, v4
    v_and_b32 v17, 7, v1
    v_lshlrev_b32 v17, 2, v17
    v_xor_b32 v4, v4, v17
    v_lshlrev_b32 v4, 2, v4
    v_lshl_add_u32 v4, v19, 9, v4
    v_lshl_add_u32 v4, v5, 8, v4
    v_add_u32 v4, 147968, v4
    v_xor_b32 v5, 16, v4
    v_bfe_u32 v2, v0, 3, 4
    v_and_b32 v13, 7, v0
    v_lshlrev_b32 v3, 1, v13
    v_xor_b32 v3, v3, v2
    v_lshlrev_b32 v3, 4, v3
    v_lshl_add_u32 v14, v2, 8, v3
    v_lshrrev_b32 v2, 7, v0
    v_lshl_add_u32 v14, v2, 14, v14
    v_xor_b32 v15, 16, v14
    v_bfe_u32 v3, v0, 5, 3
    v_xor_b32 v13, v13, v3
    v_lshlrev_b32 v13, 4, v13
    v_lshrrev_b32 v2, 3, v0
    v_lshl_add_u32 v13, v2, 7, v13
    v_add_u32 v13, 147968, v13
    s_mov_b32 s62, 0x1000000
    s_nop 1
    s_branch L_WT_R
L_WT:
    s_sleep 4
L_WT_R:
    ds_read_b32 v19, v6 offset:28
    s_waitcnt lgkmcnt(0)
    v_readfirstlane_b32 s55, v19
    s_sub_u32 s62, s62, 1
    s_cselect_b32 s55, 1, s55
    s_cmp_lt_u32 s55, 1
    s_cbranch_scc1 L_WT
    s_mov_b32 s62, 0x80000
L_P3:
    buffer_load_dwordx4 v[44:47], v18, s[12:15], s65 offen sc1
    buffer_load_dwordx4 v[48:51], v18, s[12:15], s66 offen sc1
    buffer_load_dwordx4 v[52:55], v18, s[12:15], s67 offen sc1
    buffer_load_dwordx4 v[56:59], v18, s[12:15], s68 offen sc1
    s_waitcnt vmcnt(0)
L_P3_C:
    v_cmp_ne_u32 vcc, s61, v45
    v_cmp_ne_u32 s[42:43], s61, v47
    s_nop 0
    s_or_b64 vcc, vcc, s[42:43]
    v_cmp_ne_u32 s[42:43], s61, v49
    s_nop 0
    s_or_b64 vcc, vcc, s[42:43]
    v_cmp_ne_u32 s[42:43], s61, v51
    s_nop 0
    s_or_b64 vcc, vcc, s[42:43]
    v_cmp_ne_u32 s[42:43], s61, v53
    s_nop 0
    s_or_b64 vcc, vcc, s[42:43]
    v_cmp_ne_u32 s[42:43], s61, v55
    s_nop 0
    s_or_b64 vcc, vcc, s[42:43]
    v_cmp_ne_u32 s[42:43], s61, v57
    s_nop 0
    s_or_b64 vcc, vcc, s[42:43]
    v_cmp_ne_u32 s[42:43], s61, v59
    s_nop 0
    s_or_b64 vcc, vcc, s[42:43]
    s_cmp_eq_u64 vcc, 0
    s_cbranch_scc1 L_P3_D
    s_sub_u32 s62, s62, 1
    s_cbranch_scc1 L_P3_D
    s_sleep 12
    s_branch L_P3
L_P3_D:
    ds_write_b32 v4, v44 offset:0
    ds_write_b32 v4, v46 offset:128
    ds_write_b32 v4, v48 offset:8
    ds_write_b32 v4, v50 offset:136
    ds_write_b32 v5, v52 offset:0
    ds_write_b32 v5, v54 offset:128
    ds_write_b32 v5, v56 offset:8
    ds_write_b32 v5, v58 offset:136
    s_branch L_FINAL
L_H2:
    s_mov_b32 s12, s40
    s_and_b32 s13, s41, 0xffff
    s_mov_b32 s14, 0xe00000
    s_mov_b32 s15, 0x00020000
    s_mov_b32 s44, s34
    s_and_b32 s45, s35, 0xffff
    s_mov_b32 s46, 0x1c0000
    s_mov_b32 s47, 0x00020000
    s_mov_b32 s48, s36
    s_and_b32 s49, s37, 0xffff
    s_mov_b32 s50, 0x200000
    s_mov_b32 s51, 0x00020000
    v_bfe_u32 v36, v1, 4, 1
    v_bfe_u32 v37, v1, 2, 2
    v_lshl_or_b32 v38, v36, 2, v37
    v_lshl_add_u32 v36, v36, 3, v37
    v_lshrrev_b32 v37, 5, v1
    v_lshl_add_u32 v36, v37, 2, v36
    v_and_b32 v37, 3, v1
    v_lshlrev_b32 v37, 3, v37
    v_lshl_add_u32 v39, v36, 8, v37
    s_add_u32 s55, s67, 65536
    v_add_u32 v39, s55, v39
    v_xor_b32 v36, 0, v38
    v_lshl_add_u32 v24, v36, 5, v39
    v_xor_b32 v36, 1, v38
    v_lshl_add_u32 v25, v36, 5, v39
    v_xor_b32 v36, 2, v38
    v_lshl_add_u32 v26, v36, 5, v39
    v_xor_b32 v36, 3, v38
    v_lshl_add_u32 v27, v36, 5, v39
    v_xor_b32 v36, 4, v38
    v_lshl_add_u32 v28, v36, 5, v39
    v_xor_b32 v36, 5, v38
    v_lshl_add_u32 v29, v36, 5, v39
    v_xor_b32 v36, 6, v38
    v_lshl_add_u32 v30, v36, 5, v39
    v_mov_b32 v32, 0x3f803f80
    v_mov_b32 v33, 0x3f803f80
    v_mov_b32 v34, 0x3f803f80
    v_mov_b32 v35, 0x3f803f80
    v_lshlrev_b32 v48, 4, v1
    v_add_u32 v49, 57344, v48
    v_add_u32 v50, 114688, v48
    v_add_u32 v51, 172032, v48
    s_mul_i32 s30, s63, 229376
    s_mul_i32 s55, s52, 14336
    s_add_u32 s30, s30, s55
    v_lshrrev_b32 v36, 3, v1
    v_bfe_u32 v37, v1, 4, 1
    v_lshlrev_b32 v37, 1, v37
    v_and_b32 v38, 7, v1
    v_xor_b32 v38, v38, v37
    v_lshlrev_b32 v38, 4, v38
    v_lshl_add_u32 v52, v36, 10, v38
    v_xor_b32 v39, 64, v52
    v_add_u32 v53, 7168, v39
    v_add_u32 v54, 14336, v52
    v_add_u32 v55, 21504, v39
    s_mul_i32 s31, s52, 458752
    s_lshl_b32 s55, s64, 7
    s_add_u32 s31, s31, s55
    s_mov_b32 s39, s3
    s_mov_b32 s38, s3
    v_lshrrev_b32 v36, 4, v1
    v_bfe_u32 v37, v1, 2, 2
    v_lshl_add_u32 v36, v36, 3, v37
    v_bfe_u32 v37, v1, 3, 2
    v_and_b32 v38, 3, v1
    v_lshlrev_b32 v38, 3, v38
    v_lshl_add_u32 v38, v36, 7, v38
    v_add_u32 v38, s67, v38
    v_xor_b32 v39, 0, v37
    v_lshl_add_u32 v56, v39, 5, v38
    v_xor_b32 v39, 1, v37
    v_lshl_add_u32 v57, v39, 5, v38
    v_xor_b32 v39, 2, v37
    v_lshl_add_u32 v58, v39, 5, v38
    v_xor_b32 v39, 3, v37
    v_lshl_add_u32 v59, v39, 5, v38
    v_add_u32 v60, 65536, v56
    v_add_u32 v61, 65536, v57
    v_add_u32 v62, 65536, v58
    v_add_u32 v63, 65536, v59
    v_mov_b32 v6, 163328
    v_mov_b32 v7, 1
    v_mov_b32 v238, 0
    v_mov_b32 v239, 0
    v_mov_b32 v242, 0
    v_mov_b32 v243, 0
    v_mov_b32 v246, 0
    v_mov_b32 v247, 0
    s_lshl_b32 s55, s3, 5
    s_add_u32 s55, s55, 64
    s_mul_i32 s56, s52, 458752
    s_lshl_b32 s57, s64, 7
    s_add_u32 s56, s56, s57
    v_min_u32 v36, 47, v1
    v_add_u32 v36, s55, v36
    v_subrev_u32 v37, 448, v36
    v_cmp_gt_u32 vcc, 448, v36
    s_nop 1
    v_cndmask_b32 v36, v37, v36, vcc
    v_lshl_add_u32 v46, v36, 10, s56
    v_and_b32 v36, 31, v1
    v_lshlrev_b32 v2, 3, v36
    s_lshl_b32 s69, s53, 10
    s_lshl_b32 s56, s52, 8
    s_add_u32 s69, s69, s56
    s_add_u32 s69, s69, 13631488
    s_lshr_b32 s16, s60, 6
    s_lshl_b32 s16, s16, 10
    s_add_u32 s16, s16, s56
    s_add_u32 s16, s16, 13647872
    v_lshlrev_b32 v41, 2, v1
    s_waitcnt vmcnt(9)
    v_lshlrev_b32 v64, 16, v64
    v_lshlrev_b32 v65, 16, v65
    v_lshlrev_b32 v66, 16, v66
    v_lshlrev_b32 v67, 16, v67
    v_lshlrev_b32 v68, 16, v68
    v_lshlrev_b32 v69, 16, v69
    v_lshlrev_b32 v70, 16, v70
    v_mul_f32 v72, 0x3fb8aa3b, v70
    v_mul_f32 v73, 0x3fb8aa3b, v64
    v_exp_f32 v72, v72
    v_exp_f32 v73, v73
    v_max3_f32 v78, |v66|, |v67|, |v68|
    v_max_f32_e64 v78, v78, |v69|
    v_cvt_pk_bf16_f32 v72, v72, v72
    s_nop 0
    v_max_f32_dpp v78, v78, v78 row_ror:1 row_mask:0xf bank_mask:0xf
    v_lshlrev_b32 v72, 16, v72
    v_cvt_pk_bf16_f32 v73, v73, v73
    v_max_f32_dpp v78, v78, v78 row_ror:2 row_mask:0xf bank_mask:0xf
    v_lshlrev_b32 v73, 16, v73
    v_mul_f32 v73, v73, v72
    v_max_f32_dpp v78, v78, v78 row_ror:4 row_mask:0xf bank_mask:0xf
    v_mul_f32 v74, v65, v72
    v_mul_f32 v73, 0xbfb8aa3b, v73
    v_max_f32_dpp v78, v78, v78 row_ror:8 row_mask:0xf bank_mask:0xf
    v_mul_f32 v74, 0x3e22f983, v74
    v_mul_f32 v98, 0x41000000, v73
    v_mov_b32 v79, v78
    v_mul_f32 v100, 0x43000000, v73
    v_mul_f32 v99, 0xc1000000, v74
    v_permlane16_swap_b32 v78, v79
    v_mul_f32 v101, 0xc3000000, v74
    v_max_f32 v78, v78, v79
    v_exp_f32 v98, v98
    v_mov_b32 v79, v78
    v_exp_f32 v100, v100
    v_fract_f32 v99, v99
    v_permlane32_swap_b32 v78, v79
    v_fract_f32 v101, v101
    v_max_f32 v78, v78, v79
    v_cos_f32 v92, v99
    v_lshrrev_b32 v78, 23, v78
    v_cos_f32 v96, v101
    v_min_u32 v78, 253, v78
    v_sin_f32 v93, v99
    v_sub_u32 v79, 254, v78
    v_sin_f32 v97, v101
    v_lshlrev_b32 v79, 23, v79
    v_mul_f32 v92, v92, v98
    v_lshlrev_b32 v78, 23, v78
    v_mul_f32 v96, v96, v100
    v_mul_f32 v80, v66, v79
    v_mul_f32 v93, v93, v98
    v_mul_f32 v81, v67, v79
    v_mul_f32 v97, v97, v100
    v_mul_f32 v114, v78, v72
    v_mul_f32 v102, 0x3f800000, v73
    v_add_f32 v114, v114, v114
    v_mul_f32 v104, 0x43800000, v73
    v_mul_f32 v103, 0x3f800000, v74
    v_mul_f32 v105, 0x43800000, v74
    v_exp_f32 v102, v102
    v_exp_f32 v104, v104
    v_fract_f32 v103, v103
    v_fract_f32 v105, v105
    v_cos_f32 v82, v103
    v_cos_f32 v90, v105
    v_sin_f32 v83, v103
    v_sin_f32 v91, v105
    v_mul_f32 v82, v82, v102
    v_mul_f32 v90, v90, v104
    v_mul_f32 v83, v83, v102
    v_mul_f32 v91, v91, v104
    v_pk_mul_f32 v[94:95], v[92:93], v[92:93] op_sel:[0,0] op_sel_hi:[0,1]
    v_pk_fma_f32 v[94:95], v[92:93], v[92:93], v[94:95] op_sel:[1,1,0] op_sel_hi:[1,0,1] neg_lo:[1,0,0]
    v_pk_mul_f32 v[84:85], v[82:83], v[82:83] op_sel:[0,0] op_sel_hi:[0,1]
    v_pk_fma_f32 v[84:85], v[82:83], v[82:83], v[84:85] op_sel:[1,1,0] op_sel_hi:[1,0,1] neg_lo:[1,0,0]
    v_mov_b32 v88, v92
    v_xor_b32 v89, 0x80000000, v93
    v_pk_mul_f32 v[86:87], v[84:85], v[84:85] op_sel:[0,0] op_sel_hi:[0,1]
    v_pk_fma_f32 v[86:87], v[84:85], v[84:85], v[86:87] op_sel:[1,1,0] op_sel_hi:[1,0,1] neg_lo:[1,0,0]
    v_mov_b32 v128, 0x3c00
    v_pk_mul_f32 v[108:109], v[92:93], v[96:97] op_sel:[0,0] op_sel_hi:[0,1]
    v_cvt_pk_f16_f32 v144, v96, v97
    v_pk_fma_f32 v[108:109], v[92:93], v[96:97], v[108:109] op_sel:[1,1,0] op_sel_hi:[1,0,1] neg_lo:[1,0,0]
    v_pk_mul_f32 v[102:103], v[94:95], v[96:97] op_sel:[0,0] op_sel_hi:[0,1]
    v_cvt_pk_f16_f32 v129, v92, v93
    v_pk_fma_f32 v[102:103], v[94:95], v[96:97], v[102:103] op_sel:[1,1,0] op_sel_hi:[1,0,1] neg_lo:[1,0,0]
    v_cvt_pk_f16_f32 v145, v108, v109
    v_cvt_pk_f16_f32 v130, v94, v95
    v_pk_mul_f32 v[104:105], v[92:93], v[94:95] op_sel:[0,0] op_sel_hi:[0,1]
    v_cvt_pk_f16_f32 v146, v102, v103
    v_pk_fma_f32 v[104:105], v[92:93], v[94:95], v[104:105] op_sel:[1,1,0] op_sel_hi:[1,0,1] neg_lo:[1,0,0]
    v_pk_mul_f32 v[98:99], v[94:95], v[94:95] op_sel:[0,0] op_sel_hi:[0,1]
    v_pk_mul_f32 v[108:109], v[104:105], v[96:97] op_sel:[0,0] op_sel_hi:[0,1]
    v_pk_fma_f32 v[98:99], v[94:95], v[94:95], v[98:99] op_sel:[1,1,0] op_sel_hi:[1,0,1] neg_lo:[1,0,0]
    v_pk_fma_f32 v[108:109], v[104:105], v[96:97], v[108:109] op_sel:[1,1,0] op_sel_hi:[1,0,1] neg_lo:[1,0,0]
    v_pk_mul_f32 v[102:103], v[98:99], v[96:97] op_sel:[0,0] op_sel_hi:[0,1]
    v_cvt_pk_f16_f32 v131, v104, v105
    v_pk_fma_f32 v[102:103], v[98:99], v[96:97], v[102:103] op_sel:[1,1,0] op_sel_hi:[1,0,1] neg_lo:[1,0,0]
    v_cvt_pk_f16_f32 v147, v108, v109
    v_cvt_pk_f16_f32 v132, v98, v99
    v_pk_mul_f32 v[106:107], v[104:105], v[94:95] op_sel:[0,0] op_sel_hi:[0,1]
    v_cvt_pk_f16_f32 v148, v102, v103
    v_pk_fma_f32 v[106:107], v[104:105], v[94:95], v[106:107] op_sel:[1,1,0] op_sel_hi:[1,0,1] neg_lo:[1,0,0]
    v_pk_mul_f32 v[100:101], v[98:99], v[94:95] op_sel:[0,0] op_sel_hi:[0,1]
    v_pk_mul_f32 v[108:109], v[106:107], v[96:97] op_sel:[0,0] op_sel_hi:[0,1]
    v_pk_fma_f32 v[100:101], v[98:99], v[94:95], v[100:101] op_sel:[1,1,0] op_sel_hi:[1,0,1] neg_lo:[1,0,0]
    v_pk_fma_f32 v[108:109], v[106:107], v[96:97], v[108:109] op_sel:[1,1,0] op_sel_hi:[1,0,1] neg_lo:[1,0,0]
    v_pk_mul_f32 v[102:103], v[100:101], v[96:97] op_sel:[0,0] op_sel_hi:[0,1]
    v_cvt_pk_f16_f32 v133, v106, v107
    v_pk_fma_f32 v[102:103], v[100:101], v[96:97], v[102:103] op_sel:[1,1,0] op_sel_hi:[1,0,1] neg_lo:[1,0,0]
    v_cvt_pk_f16_f32 v149, v108, v109
    v_cvt_pk_f16_f32 v134, v100, v101
    v_pk_mul_f32 v[104:105], v[106:107], v[94:95] op_sel:[0,0] op_sel_hi:[0,1]
    v_cvt_pk_f16_f32 v150, v102, v103
    v_pk_fma_f32 v[104:105], v[106:107], v[94:95], v[104:105] op_sel:[1,1,0] op_sel_hi:[1,0,1] neg_lo:[1,0,0]
    v_pk_mul_f32 v[98:99], v[100:101], v[94:95] op_sel:[0,0] op_sel_hi:[0,1]
    v_pk_mul_f32 v[108:109], v[104:105], v[96:97] op_sel:[0,0] op_sel_hi:[0,1]
    v_pk_fma_f32 v[98:99], v[100:101], v[94:95], v[98:99] op_sel:[1,1,0] op_sel_hi:[1,0,1] neg_lo:[1,0,0]
    v_pk_fma_f32 v[108:109], v[104:105], v[96:97], v[108:109] op_sel:[1,1,0] op_sel_hi:[1,0,1] neg_lo:[1,0,0]
    v_pk_mul_f32 v[102:103], v[98:99], v[96:97] op_sel:[0,0] op_sel_hi:[0,1]
    v_cvt_pk_f16_f32 v135, v104, v105
    v_pk_fma_f32 v[102:103], v[98:99], v[96:97], v[102:103] op_sel:[1,1,0] op_sel_hi:[1,0,1] neg_lo:[1,0,0]
    v_cvt_pk_f16_f32 v151, v108, v109
    v_cvt_pk_f16_f32 v136, v98, v99
    v_pk_mul_f32 v[106:107], v[104:105], v[94:95] op_sel:[0,0] op_sel_hi:[0,1]
    v_cvt_pk_f16_f32 v152, v102, v103
    v_pk_fma_f32 v[106:107], v[104:105], v[94:95], v[106:107] op_sel:[1,1,0] op_sel_hi:[1,0,1] neg_lo:[1,0,0]
    v_pk_mul_f32 v[100:101], v[98:99], v[94:95] op_sel:[0,0] op_sel_hi:[0,1]
    v_pk_mul_f32 v[108:109], v[106:107], v[96:97] op_sel:[0,0] op_sel_hi:[0,1]
    v_pk_fma_f32 v[100:101], v[98:99], v[94:95], v[100:101] op_sel:[1,1,0] op_sel_hi:[1,0,1] neg_lo:[1,0,0]
    v_pk_fma_f32 v[108:109], v[106:107], v[96:97], v[108:109] op_sel:[1,1,0] op_sel_hi:[1,0,1] neg_lo:[1,0,0]
    v_pk_mul_f32 v[102:103], v[100:101], v[96:97] op_sel:[0,0] op_sel_hi:[0,1]
    v_cvt_pk_f16_f32 v137, v106, v107
    v_pk_fma_f32 v[102:103], v[100:101], v[96:97], v[102:103] op_sel:[1,1,0] op_sel_hi:[1,0,1] neg_lo:[1,0,0]
    v_cvt_pk_f16_f32 v153, v108, v109
    v_cvt_pk_f16_f32 v138, v100, v101
    v_pk_mul_f32 v[104:105], v[106:107], v[94:95] op_sel:[0,0] op_sel_hi:[0,1]
    v_cvt_pk_f16_f32 v154, v102, v103
    v_pk_fma_f32 v[104:105], v[106:107], v[94:95], v[104:105] op_sel:[1,1,0] op_sel_hi:[1,0,1] neg_lo:[1,0,0]
    v_pk_mul_f32 v[98:99], v[100:101], v[94:95] op_sel:[0,0] op_sel_hi:[0,1]
    v_pk_mul_f32 v[108:109], v[104:105], v[96:97] op_sel:[0,0] op_sel_hi:[0,1]
    v_pk_fma_f32 v[98:99], v[100:101], v[94:95], v[98:99] op_sel:[1,1,0] op_sel_hi:[1,0,1] neg_lo:[1,0,0]
    v_pk_fma_f32 v[108:109], v[104:105], v[96:97], v[108:109] op_sel:[1,1,0] op_sel_hi:[1,0,1] neg_lo:[1,0,0]
    v_pk_mul_f32 v[102:103], v[98:99], v[96:97] op_sel:[0,0] op_sel_hi:[0,1]
    v_cvt_pk_f16_f32 v139, v104, v105
    v_pk_fma_f32 v[102:103], v[98:99], v[96:97], v[102:103] op_sel:[1,1,0] op_sel_hi:[1,0,1] neg_lo:[1,0,0]
    v_cvt_pk_f16_f32 v155, v108, v109
    v_cvt_pk_f16_f32 v140, v98, v99
    v_pk_mul_f32 v[106:107], v[104:105], v[94:95] op_sel:[0,0] op_sel_hi:[0,1]
    v_cvt_pk_f16_f32 v156, v102, v103
    v_pk_fma_f32 v[106:107], v[104:105], v[94:95], v[106:107] op_sel:[1,1,0] op_sel_hi:[1,0,1] neg_lo:[1,0,0]
    v_pk_mul_f32 v[100:101], v[98:99], v[94:95] op_sel:[0,0] op_sel_hi:[0,1]
    v_pk_mul_f32 v[108:109], v[106:107], v[96:97] op_sel:[0,0] op_sel_hi:[0,1]
    v_pk_fma_f32 v[100:101], v[98:99], v[94:95], v[100:101] op_sel:[1,1,0] op_sel_hi:[1,0,1] neg_lo:[1,0,0]
    v_pk_fma_f32 v[108:109], v[106:107], v[96:97], v[108:109] op_sel:[1,1,0] op_sel_hi:[1,0,1] neg_lo:[1,0,0]
    v_pk_mul_f32 v[102:103], v[100:101], v[96:97] op_sel:[0,0] op_sel_hi:[0,1]
    v_cvt_pk_f16_f32 v141, v106, v107
    v_pk_fma_f32 v[102:103], v[100:101], v[96:97], v[102:103] op_sel:[1,1,0] op_sel_hi:[1,0,1] neg_lo:[1,0,0]
    v_cvt_pk_f16_f32 v157, v108, v109
    v_cvt_pk_f16_f32 v142, v100, v101
    v_pk_mul_f32 v[104:105], v[106:107], v[94:95] op_sel:[0,0] op_sel_hi:[0,1]
    v_cvt_pk_f16_f32 v158, v102, v103
    v_pk_fma_f32 v[104:105], v[106:107], v[94:95], v[104:105] op_sel:[1,1,0] op_sel_hi:[1,0,1] neg_lo:[1,0,0]
    v_pk_mul_f32 v[108:109], v[104:105], v[96:97] op_sel:[0,0] op_sel_hi:[0,1]
    v_pk_fma_f32 v[108:109], v[104:105], v[96:97], v[108:109] op_sel:[1,1,0] op_sel_hi:[1,0,1] neg_lo:[1,0,0]
    v_cvt_pk_f16_f32 v143, v104, v105
    v_cvt_pk_f16_f32 v159, v108, v109
    v_pk_mul_f32 v[112:113], v[80:81], v[90:91] op_sel:[0,0] op_sel_hi:[0,1]
    v_pk_fma_f32 v[112:113], v[80:81], v[90:91], v[112:113] op_sel:[1,1,0] op_sel_hi:[1,0,1] neg_lo:[1,0,0]
    v_cvt_pk_f16_f32 v164, v112, v113
    s_add_u32 s17, s59, 1
    s_and_b32 s17, s17, 7
    s_lshl_b32 s28, s17, 7
    s_add_u32 s28, s28, s65
    s_add_u32 m0, s67, 16384
    s_mul_i32 s29, s17, 229376
    s_add_u32 s29, s29, s66
    buffer_load_dwordx4 v16, s[4:7], s28 offen offset:0 lds
    v_cvt_pk_f16_f32 v160, v80, v81
    v_cvt_pk_f16_f32 v165, v112, v113
    v_pk_mul_f32 v[98:99], v[80:81], v[82:83] op_sel:[0,0] op_sel_hi:[0,1]
    v_pk_mul_f32 v[106:107], v[112:113], v[90:91] op_sel:[0,0] op_sel_hi:[0,1]
    v_pk_fma_f32 v[98:99], v[80:81], v[82:83], v[98:99] op_sel:[1,1,0] op_sel_hi:[1,0,1] neg_lo:[1,0,0]
    v_pk_fma_f32 v[106:107], v[112:113], v[90:91], v[106:107] op_sel:[1,1,0] op_sel_hi:[1,0,1] neg_lo:[1,0,0]
    v_cvt_pk_f16_f32 v161, v98, v99
    v_cvt_pk_f16_f32 v176, v106, v107
    v_pk_mul_f32 v[100:101], v[98:99], v[82:83] op_sel:[0,0] op_sel_hi:[0,1]
    v_pk_mul_f32 v[110:111], v[106:107], v[86:87] op_sel:[0,0] op_sel_hi:[0,1]
    v_pk_fma_f32 v[100:101], v[98:99], v[82:83], v[100:101] op_sel:[1,1,0] op_sel_hi:[1,0,1] neg_lo:[1,0,0]
    v_pk_fma_f32 v[110:111], v[106:107], v[86:87], v[110:111] op_sel:[1,1,0] op_sel_hi:[1,0,1] neg_lo:[1,0,0]
    buffer_load_dwordx4 v17, s[4:7], s28 offen offset:1024 lds
    v_cvt_pk_f16_f32 v162, v100, v101
    v_cvt_pk_f16_f32 v177, v110, v111
    v_pk_mul_f32 v[98:99], v[100:101], v[82:83] op_sel:[0,0] op_sel_hi:[0,1]
    v_pk_mul_f32 v[110:111], v[106:107], v[88:89] op_sel:[0,0] op_sel_hi:[0,1]
    v_pk_fma_f32 v[98:99], v[100:101], v[82:83], v[98:99] op_sel:[1,1,0] op_sel_hi:[1,0,1] neg_lo:[1,0,0]
    v_pk_fma_f32 v[110:111], v[106:107], v[88:89], v[110:111] op_sel:[1,1,0] op_sel_hi:[1,0,1] neg_lo:[1,0,0]
    v_cvt_pk_f16_f32 v163, v98, v99
    v_cvt_pk_f16_f32 v178, v110, v111
    v_pk_mul_f32 v[100:101], v[98:99], v[82:83] op_sel:[0,0] op_sel_hi:[0,1]
    v_pk_mul_f32 v[108:109], v[106:107], v[90:91] op_sel:[0,0] op_sel_hi:[0,1]
    v_pk_fma_f32 v[100:101], v[98:99], v[82:83], v[100:101] op_sel:[1,1,0] op_sel_hi:[1,0,1] neg_lo:[1,0,0]
    v_pk_fma_f32 v[108:109], v[106:107], v[90:91], v[108:109] op_sel:[1,1,0] op_sel_hi:[1,0,1] neg_lo:[1,0,0]
    buffer_load_dwordx4 v18, s[4:7], s28 offen offset:2048 lds
    v_cvt_pk_f16_f32 v168, v100, v101
    v_cvt_pk_f16_f32 v180, v108, v109
    v_pk_mul_f32 v[98:99], v[100:101], v[82:83] op_sel:[0,0] op_sel_hi:[0,1]
    v_pk_mul_f32 v[110:111], v[108:109], v[86:87] op_sel:[0,0] op_sel_hi:[0,1]
    v_pk_fma_f32 v[98:99], v[100:101], v[82:83], v[98:99] op_sel:[1,1,0] op_sel_hi:[1,0,1] neg_lo:[1,0,0]
    v_pk_fma_f32 v[110:111], v[108:109], v[86:87], v[110:111] op_sel:[1,1,0] op_sel_hi:[1,0,1] neg_lo:[1,0,0]
    v_cvt_pk_f16_f32 v169, v98, v99
    v_cvt_pk_f16_f32 v181, v110, v111
    v_pk_mul_f32 v[100:101], v[98:99], v[82:83] op_sel:[0,0] op_sel_hi:[0,1]
    v_pk_mul_f32 v[110:111], v[108:109], v[88:89] op_sel:[0,0] op_sel_hi:[0,1]
    v_pk_fma_f32 v[100:101], v[98:99], v[82:83], v[100:101] op_sel:[1,1,0] op_sel_hi:[1,0,1] neg_lo:[1,0,0]
    v_pk_fma_f32 v[110:111], v[108:109], v[88:89], v[110:111] op_sel:[1,1,0] op_sel_hi:[1,0,1] neg_lo:[1,0,0]
    buffer_load_dwordx4 v19, s[4:7], s28 offen offset:3072 lds
    v_cvt_pk_f16_f32 v170, v100, v101
    v_cvt_pk_f16_f32 v182, v110, v111
    v_pk_mul_f32 v[98:99], v[100:101], v[82:83] op_sel:[0,0] op_sel_hi:[0,1]
    v_pk_mul_f32 v[106:107], v[108:109], v[90:91] op_sel:[0,0] op_sel_hi:[0,1]
    v_pk_fma_f32 v[98:99], v[100:101], v[82:83], v[98:99] op_sel:[1,1,0] op_sel_hi:[1,0,1] neg_lo:[1,0,0]
    v_pk_fma_f32 v[106:107], v[108:109], v[90:91], v[106:107] op_sel:[1,1,0] op_sel_hi:[1,0,1] neg_lo:[1,0,0]
    v_cvt_pk_f16_f32 v171, v98, v99
    v_cvt_pk_f16_f32 v179, v106, v107
    v_pk_mul_f32 v[102:103], v[112:113], v[84:85] op_sel:[0,0] op_sel_hi:[0,1]
    v_pk_mul_f32 v[110:111], v[106:107], v[88:89] op_sel:[0,0] op_sel_hi:[0,1]
    v_pk_fma_f32 v[102:103], v[112:113], v[84:85], v[102:103] op_sel:[1,1,0] op_sel_hi:[1,0,1] neg_lo:[1,0,0]
    v_pk_fma_f32 v[110:111], v[106:107], v[88:89], v[110:111] op_sel:[1,1,0] op_sel_hi:[1,0,1] neg_lo:[1,0,0]
    s_add_u32 m0, s67, 81920
    s_nop 0
    buffer_load_dwordx4 v20, s[8:11], s29 offen offset:0 lds
    v_cvt_pk_f16_f32 v166, v102, v103
    v_cvt_pk_f16_f32 v184, v110, v111
    v_pk_mul_f32 v[104:105], v[102:103], v[84:85] op_sel:[0,0] op_sel_hi:[0,1]
    v_pk_mul_f32 v[108:109], v[106:107], v[90:91] op_sel:[0,0] op_sel_hi:[0,1]
    v_pk_fma_f32 v[104:105], v[102:103], v[84:85], v[104:105] op_sel:[1,1,0] op_sel_hi:[1,0,1] neg_lo:[1,0,0]
    v_pk_fma_f32 v[108:109], v[106:107], v[90:91], v[108:109] op_sel:[1,1,0] op_sel_hi:[1,0,1] neg_lo:[1,0,0]
    v_cvt_pk_f16_f32 v167, v104, v105
    v_cvt_pk_f16_f32 v183, v108, v109
    v_cvt_pk_f16_f32 v172, v104, v105
    v_pk_mul_f32 v[110:111], v[108:109], v[88:89] op_sel:[0,0] op_sel_hi:[0,1]
    v_cvt_pk_f16_f32 v173, v104, v105
    v_pk_fma_f32 v[110:111], v[108:109], v[88:89], v[110:111] op_sel:[1,1,0] op_sel_hi:[1,0,1] neg_lo:[1,0,0]
    buffer_load_dwordx4 v21, s[8:11], s29 offen offset:1024 lds
    v_pk_mul_f32 v[102:103], v[104:105], v[84:85] op_sel:[0,0] op_sel_hi:[0,1]
    v_cvt_pk_f16_f32 v188, v110, v111
    v_pk_fma_f32 v[102:103], v[104:105], v[84:85], v[102:103] op_sel:[1,1,0] op_sel_hi:[1,0,1] neg_lo:[1,0,0]
    v_pk_mul_f32 v[106:107], v[108:109], v[90:91] op_sel:[0,0] op_sel_hi:[0,1]
    v_cvt_pk_f16_f32 v174, v102, v103
    v_pk_fma_f32 v[106:107], v[108:109], v[90:91], v[106:107] op_sel:[1,1,0] op_sel_hi:[1,0,1] neg_lo:[1,0,0]
    v_pk_mul_f32 v[104:105], v[102:103], v[84:85] op_sel:[0,0] op_sel_hi:[0,1]
    v_cvt_pk_f16_f32 v185, v106, v107
    v_pk_fma_f32 v[104:105], v[102:103], v[84:85], v[104:105] op_sel:[1,1,0] op_sel_hi:[1,0,1] neg_lo:[1,0,0]
    v_pk_mul_f32 v[110:111], v[106:107], v[88:89] op_sel:[0,0] op_sel_hi:[0,1]
    v_cvt_pk_f16_f32 v175, v104, v105
    v_pk_fma_f32 v[110:111], v[106:107], v[88:89], v[110:111] op_sel:[1,1,0] op_sel_hi:[1,0,1] neg_lo:[1,0,0]
    buffer_load_dwordx4 v22, s[8:11], s29 offen offset:2048 lds
    v_cvt_pk_f16_f32 v186, v110, v111
    v_pk_mul_f32 v[108:109], v[106:107], v[90:91] op_sel:[0,0] op_sel_hi:[0,1]
    v_pk_fma_f32 v[108:109], v[106:107], v[90:91], v[108:109] op_sel:[1,1,0] op_sel_hi:[1,0,1] neg_lo:[1,0,0]
    v_cvt_pk_f16_f32 v189, v108, v109
    v_pk_mul_f32 v[110:111], v[108:109], v[88:89] op_sel:[0,0] op_sel_hi:[0,1]
    v_pk_fma_f32 v[110:111], v[108:109], v[88:89], v[110:111] op_sel:[1,1,0] op_sel_hi:[1,0,1] neg_lo:[1,0,0]
    v_cvt_pk_f16_f32 v190, v110, v111
    v_mov_b32 v187, 0
    v_mov_b32 v191, 0
    buffer_load_dwordx4 v23, s[8:11], s29 offen offset:3072 lds
    s_add_u32 s17, s59, 2
    s_and_b32 s17, s17, 7
    s_lshl_b32 s28, s17, 7
    s_add_u32 s28, s28, s65
    s_add_u32 m0, s67, 32768
    s_mul_i32 s29, s17, 229376
    s_add_u32 s29, s29, s66
    buffer_load_dwordx4 v16, s[4:7], s28 offen offset:0 lds
    buffer_load_dwordx4 v17, s[4:7], s28 offen offset:1024 lds
    buffer_load_dwordx4 v18, s[4:7], s28 offen offset:2048 lds
    buffer_load_dwordx4 v19, s[4:7], s28 offen offset:3072 lds
    s_add_u32 m0, s67, 98304
    s_nop 0
    buffer_load_dwordx4 v20, s[8:11], s29 offen offset:0 lds
    buffer_load_dwordx4 v21, s[8:11], s29 offen offset:1024 lds
    buffer_load_dwordx4 v22, s[8:11], s29 offen offset:2048 lds
    buffer_load_dwordx4 v23, s[8:11], s29 offen offset:3072 lds
    s_waitcnt vmcnt(17)
    s_barrier
    s_add_u32 s17, s59, 3
    s_and_b32 s17, s17, 7
    s_lshl_b32 s28, s17, 7
    s_add_u32 s28, s28, s65
    s_add_u32 m0, s67, 49152
    s_mul_i32 s29, s17, 229376
    s_add_u32 s29, s29, s66
    buffer_load_dwordx4 v16, s[4:7], s28 offen offset:0 lds
    buffer_load_dwordx4 v17, s[4:7], s28 offen offset:1024 lds
    buffer_load_dwordx4 v18, s[4:7], s28 offen offset:2048 lds
    ds_read_b32 v15, v6 offset:32
    ds_read_b64_tr_b16 v[220:221], v24 offset:0
    ds_read_b64_tr_b16 v[224:225], v25 offset:0
    ds_read_b64_tr_b16 v[228:229], v26 offset:0
    ds_read_b64_tr_b16 v[232:233], v27 offset:0
    ds_read_b64_tr_b16 v[236:237], v28 offset:0
    buffer_load_dwordx4 v19, s[4:7], s28 offen offset:3072 lds
    ds_read_b64_tr_b16 v[240:241], v29 offset:0
    ds_read_b64_tr_b16 v[244:245], v30 offset:0
    s_add_u32 m0, s67, 114688
    s_nop 0
    buffer_load_dwordx4 v20, s[8:11], s29 offen offset:0 lds
    buffer_load_dwordx4 v21, s[8:11], s29 offen offset:1024 lds
    s_waitcnt lgkmcnt(0)
    v_mfma_f32_16x16x32_bf16 v[208:211], v[32:35], v[236:239], 0
    v_mfma_f32_16x16x32_bf16 v[212:215], v[32:35], v[240:243], 0
    buffer_load_dwordx4 v22, s[8:11], s29 offen offset:2048 lds
    v_mfma_f32_16x16x32_bf16 v[216:219], v[32:35], v[244:247], 0
    v_readfirstlane_b32 s61, v15
    buffer_load_dwordx4 v23, s[8:11], s29 offen offset:3072 lds
    s_waitcnt vmcnt(16)
    s_barrier
    s_add_u32 s17, s59, 4
    s_and_b32 s17, s17, 7
    s_lshl_b32 s28, s17, 7
    s_add_u32 s28, s28, s65
    s_add_u32 m0, s67, 0
    s_mul_i32 s29, s17, 229376
    s_add_u32 s29, s29, s66
    buffer_load_dwordx4 v16, s[4:7], s28 offen offset:0 lds
    buffer_load_dwordx4 v17, s[4:7], s28 offen offset:1024 lds
    buffer_load_dwordx4 v18, s[4:7], s28 offen offset:2048 lds
    ds_read_b64_tr_b16 v[222:223], v24 offset:16384
    ds_read_b64_tr_b16 v[226:227], v25 offset:16384
    ds_read_b64_tr_b16 v[230:231], v26 offset:16384
    ds_read_b64_tr_b16 v[234:235], v27 offset:16384
    ds_read_b64_tr_b16 v[238:239], v28 offset:16384
    ds_read_b64_tr_b16 v[242:243], v29 offset:16384
    buffer_load_dwordx4 v19, s[4:7], s28 offen offset:3072 lds
    ds_read_b64_tr_b16 v[246:247], v30 offset:16384
    s_add_u32 m0, s67, 65536
    s_nop 0
    buffer_load_dwordx4 v20, s[8:11], s29 offen offset:0 lds
    buffer_load_dwordx4 v21, s[8:11], s29 offen offset:1024 lds
    s_waitcnt lgkmcnt(0)
    v_mfma_f32_16x16x32_bf16 v[192:195], v[32:35], v[220:223], 0
    v_mfma_f32_16x16x32_bf16 v[196:199], v[32:35], v[224:227], 0
    buffer_load_dwordx4 v22, s[8:11], s29 offen offset:2048 lds
    v_mfma_f32_16x16x32_bf16 v[200:203], v[32:35], v[228:231], 0
    v_mfma_f32_16x16x32_bf16 v[204:207], v[32:35], v[232:235], 0
    buffer_load_dwordx4 v23, s[8:11], s29 offen offset:3072 lds
    s_waitcnt vmcnt(16)
    s_barrier
    s_add_u32 s17, s59, 5
    s_and_b32 s17, s17, 7
    s_lshl_b32 s28, s17, 7
    s_add_u32 s28, s28, s65
    s_add_u32 m0, s67, 16384
    s_mul_i32 s29, s17, 229376
    s_add_u32 s29, s29, s66
    buffer_load_dwordx4 v16, s[4:7], s28 offen offset:0 lds
    buffer_load_dwordx4 v17, s[4:7], s28 offen offset:1024 lds
    buffer_load_dwordx4 v18, s[4:7], s28 offen offset:2048 lds
    ds_read_b64_tr_b16 v[220:221], v24 offset:32768
    ds_read_b64_tr_b16 v[224:225], v25 offset:32768
    ds_read_b64_tr_b16 v[228:229], v26 offset:32768
    ds_read_b64_tr_b16 v[232:233], v27 offset:32768
    ds_read_b64_tr_b16 v[236:237], v28 offset:32768
    ds_read_b64_tr_b16 v[240:241], v29 offset:32768
    buffer_load_dwordx4 v19, s[4:7], s28 offen offset:3072 lds
    ds_read_b64_tr_b16 v[244:245], v30 offset:32768
    s_add_u32 m0, s67, 81920
    s_nop 0
    buffer_load_dwordx4 v20, s[8:11], s29 offen offset:0 lds
    buffer_load_dwordx4 v21, s[8:11], s29 offen offset:1024 lds
    s_waitcnt lgkmcnt(0)
    v_mfma_f32_16x16x32_bf16 v[208:211], v[32:35], v[236:239], v[208:211]
    v_mfma_f32_16x16x32_bf16 v[212:215], v[32:35], v[240:243], v[212:215]
    buffer_load_dwordx4 v22, s[8:11], s29 offen offset:2048 lds
    v_mfma_f32_16x16x32_bf16 v[216:219], v[32:35], v[244:247], v[216:219]
    s_waitcnt vmcnt(15)
    ds_read_b64_tr_b16 v[222:223], v24 offset:49152
    ds_read_b64_tr_b16 v[226:227], v25 offset:49152
    ds_read_b64_tr_b16 v[230:231], v26 offset:49152
    buffer_load_dwordx4 v23, s[8:11], s29 offen offset:3072 lds
    ds_read_b64_tr_b16 v[234:235], v27 offset:49152
    ds_read_b64_tr_b16 v[238:239], v28 offset:49152
    ds_read_b64_tr_b16 v[242:243], v29 offset:49152
    ds_read_b64_tr_b16 v[246:247], v30 offset:49152
    s_waitcnt lgkmcnt(0)
    v_mfma_f32_16x16x32_bf16 v[192:195], v[32:35], v[220:223], v[192:195]
    v_mfma_f32_16x16x32_bf16 v[196:199], v[32:35], v[224:227], v[196:199]
    v_mfma_f32_16x16x32_bf16 v[200:203], v[32:35], v[228:231], v[200:203]
    v_mfma_f32_16x16x32_bf16 v[204:207], v[32:35], v[232:235], v[204:207]
    s_barrier
    s_add_u32 s17, s59, 6
    s_and_b32 s17, s17, 7
    s_lshl_b32 s28, s17, 7
    s_add_u32 s28, s28, s65
    s_add_u32 m0, s67, 32768
    s_mul_i32 s29, s17, 229376
    s_add_u32 s29, s29, s66
    buffer_load_dwordx4 v16, s[4:7], s28 offen offset:0 lds
    buffer_load_dwordx4 v17, s[4:7], s28 offen offset:1024 lds
    buffer_load_dwordx4 v18, s[4:7], s28 offen offset:2048 lds
    s_waitcnt vmcnt(11)
    ds_read_b64_tr_b16 v[220:221], v24 offset:0
    ds_read_b64_tr_b16 v[224:225], v25 offset:0
    ds_read_b64_tr_b16 v[228:229], v26 offset:0
    ds_read_b64_tr_b16 v[232:233], v27 offset:0
    ds_read_b64_tr_b16 v[236:237], v28 offset:0
    ds_read_b64_tr_b16 v[240:241], v29 offset:0
    buffer_load_dwordx4 v19, s[4:7], s28 offen offset:3072 lds
    ds_read_b64_tr_b16 v[244:245], v30 offset:0
    s_add_u32 m0, s67, 98304
    s_nop 0
    buffer_load_dwordx4 v20, s[8:11], s29 offen offset:0 lds
    buffer_load_dwordx4 v21, s[8:11], s29 offen offset:1024 lds
    s_waitcnt lgkmcnt(0)
    v_mfma_f32_16x16x32_bf16 v[208:211], v[32:35], v[236:239], v[208:211]
    v_mfma_f32_16x16x32_bf16 v[212:215], v[32:35], v[240:243], v[212:215]
    buffer_load_dwordx4 v22, s[8:11], s29 offen offset:2048 lds
    v_mfma_f32_16x16x32_bf16 v[216:219], v[32:35], v[244:247], v[216:219]
    buffer_load_dwordx4 v23, s[8:11], s29 offen offset:3072 lds
    s_barrier
    s_add_u32 s17, s59, 7
    s_and_b32 s17, s17, 7
    s_lshl_b32 s28, s17, 7
    s_add_u32 s28, s28, s65
    s_add_u32 m0, s67, 49152
    s_mul_i32 s29, s17, 229376
    s_add_u32 s29, s29, s66
    buffer_load_dwordx4 v16, s[4:7], s28 offen offset:0 lds
    buffer_load_dwordx4 v17, s[4:7], s28 offen offset:1024 lds
    buffer_load_dwordx4 v18, s[4:7], s28 offen offset:2048 lds
    s_waitcnt vmcnt(11)
    ds_read_b64_tr_b16 v[222:223], v24 offset:16384
    ds_read_b64_tr_b16 v[226:227], v25 offset:16384
    ds_read_b64_tr_b16 v[230:231], v26 offset:16384
    ds_read_b64_tr_b16 v[234:235], v27 offset:16384
    ds_read_b64_tr_b16 v[238:239], v28 offset:16384
    ds_read_b64_tr_b16 v[242:243], v29 offset:16384
    buffer_load_dwordx4 v19, s[4:7], s28 offen offset:3072 lds
    ds_read_b64_tr_b16 v[246:247], v30 offset:16384
    s_add_u32 m0, s67, 114688
    s_nop 0
    buffer_load_dwordx4 v20, s[8:11], s29 offen offset:0 lds
    buffer_load_dwordx4 v21, s[8:11], s29 offen offset:1024 lds
    s_waitcnt lgkmcnt(0)
    v_mfma_f32_16x16x32_bf16 v[192:195], v[32:35], v[220:223], v[192:195]
    v_mfma_f32_16x16x32_bf16 v[196:199], v[32:35], v[224:227], v[196:199]
    buffer_load_dwordx4 v22, s[8:11], s29 offen offset:2048 lds
    v_mfma_f32_16x16x32_bf16 v[200:203], v[32:35], v[228:231], v[200:203]
    v_mfma_f32_16x16x32_bf16 v[204:207], v[32:35], v[232:235], v[204:207]
    buffer_load_dwordx4 v23, s[8:11], s29 offen offset:3072 lds
    buffer_load_dwordx2 v[4:5], v2, s[12:15], s69 offen sc1
    buffer_load_dword v40, v41, s[12:15], s16 offen sc1
    s_barrier
    s_add_u32 m0, s67, 0
    s_lshl_b32 s28, s39, 15
    s_add_u32 s28, s31, s28
    s_add_u32 s39, s39, 1
    s_cmp_eq_u32 s39, 14
    s_cselect_b32 s39, 0, s39
    buffer_load_dwordx4 v52, s[44:47], s28 offen offset:0 lds
    buffer_load_dwordx4 v53, s[44:47], s28 offen offset:1024 lds
    buffer_load_dwordx4 v54, s[44:47], s28 offen offset:2048 lds
    s_waitcnt vmcnt(13)
    ds_read_b64_tr_b16 v[220:221], v24 offset:32768
    ds_read_b64_tr_b16 v[224:225], v25 offset:32768
    ds_read_b64_tr_b16 v[228:229], v26 offset:32768
    ds_read_b64_tr_b16 v[232:233], v27 offset:32768
    ds_read_b64_tr_b16 v[236:237], v28 offset:32768
    ds_read_b64_tr_b16 v[240:241], v29 offset:32768
    buffer_load_dwordx4 v55, s[44:47], s28 offen offset:3072 lds
    ds_read_b64_tr_b16 v[244:245], v30 offset:32768
    s_add_u32 m0, s67, 65536
    s_lshl_b32 s28, s39, 15
    s_add_u32 s28, s31, s28
    s_add_u32 s39, s39, 1
    s_cmp_eq_u32 s39, 14
    s_cselect_b32 s39, 0, s39
    buffer_load_dwordx4 v52, s[44:47], s28 offen offset:0 lds
    buffer_load_dwordx4 v53, s[44:47], s28 offen offset:1024 lds
    s_waitcnt lgkmcnt(0)
    v_mfma_f32_16x16x32_bf16 v[208:211], v[32:35], v[236:239], v[208:211]
    v_mfma_f32_16x16x32_bf16 v[212:215], v[32:35], v[240:243], v[212:215]
    buffer_load_dwordx4 v54, s[44:47], s28 offen offset:2048 lds
    v_mfma_f32_16x16x32_bf16 v[216:219], v[32:35], v[244:247], v[216:219]
    s_waitcnt vmcnt(9)
    ds_read_b64_tr_b16 v[222:223], v24 offset:49152
    ds_read_b64_tr_b16 v[226:227], v25 offset:49152
    ds_read_b64_tr_b16 v[230:231], v26 offset:49152
    buffer_load_dwordx4 v55, s[44:47], s28 offen offset:3072 lds
    ds_read_b64_tr_b16 v[234:235], v27 offset:49152
    ds_read_b64_tr_b16 v[238:239], v28 offset:49152
    ds_read_b64_tr_b16 v[242:243], v29 offset:49152
    ds_read_b64_tr_b16 v[246:247], v30 offset:49152
    s_waitcnt lgkmcnt(0)
    v_mov_b32 v236, 0
    v_mov_b32 v237, 0
    v_mov_b32 v240, 0
    v_mov_b32 v241, 0
    v_mov_b32 v244, 0
    v_mov_b32 v245, 0
    v_mfma_f32_16x16x32_bf16 v[192:195], v[32:35], v[220:223], v[192:195]
    v_mfma_f32_16x16x32_bf16 v[196:199], v[32:35], v[224:227], v[196:199]
    v_mfma_f32_16x16x32_bf16 v[200:203], v[32:35], v[228:231], v[200:203]
    v_mfma_f32_16x16x32_bf16 v[204:207], v[32:35], v[232:235], v[204:207]
    v_mfma_f32_16x16x32_bf16 v[208:211], v[32:35], v[236:239], v[208:211]
    v_mfma_f32_16x16x32_bf16 v[212:215], v[32:35], v[240:243], v[212:215]
    v_mfma_f32_16x16x32_bf16 v[216:219], v[32:35], v[244:247], v[216:219]
    s_nop 1
    v_mov_b32 v220, v192
    v_mov_b32 v221, v196
    v_mov_b32 v222, v200
    v_mov_b32 v223, v204
    v_mov_b32 v224, v208
    v_mov_b32 v225, v212
    v_mov_b32 v226, v216
    s_lshl_b32 s55, s52, 9
    s_add_u32 s55, s55, 147456
    v_lshl_add_u32 v37, v1, 5, s55
    s_mov_b64 exec, 0xffff
    ds_write_b128 v37, v[220:223]
    ds_write_b128 v37, v[224:227] offset:16
    s_mov_b64 exec, -1
    s_waitcnt lgkmcnt(0)
    s_barrier
    v_and_b32 v36, 31, v1
    s_lshl_b32 s55, s52, 5
    v_add_u32 v36, s55, v36
    v_lshlrev_b32 v37, 2, v36
    v_add_u32 v37, 147456, v37
    ds_read_b32 v192, v37 offset:0
    ds_read_b32 v193, v37 offset:512
    ds_read_b32 v194, v37 offset:1024
    ds_read_b32 v195, v37 offset:1536
    v_and_b32 v37, 7, v36
    v_lshrrev_b32 v36, 3, v36
    v_lshl_add_u32 v36, v37, 4, v36
    v_lshlrev_b32 v36, 2, v36
    v_add_u32 v36, 162816, v36
    s_mov_b32 s62, 0x80000
    s_waitcnt vmcnt(9)
    s_nop 0
    s_branch L_PG_C
L_PG:
    buffer_load_dwordx2 v[4:5], v2, s[12:15], s69 offen sc1
    s_waitcnt vmcnt(0)
L_PG_C:
    v_cmp_ne_u32 vcc, s61, v5
    s_nop 0
    s_cmp_eq_u64 vcc, 0
    s_cbranch_scc1 L_PG_D
    s_sub_u32 s62, s62, 1
    s_cbranch_scc1 L_PG_D
    s_sleep 8
    s_branch L_PG
L_PG_D:
    v_and_b32 v38, 0xffff0000, v4
    v_lshlrev_b32 v39, 16, v4
    v_rcp_f32 v38, v38
    s_lshl_b32 s55, s52, 8
    s_add_u32 s55, s55, 159744
    v_add_u32 v37, s55, v2
    v_mul_f32 v38, 0xbfb8aa3b, v38
    v_mul_f32_e64 v39, -v39, v38
    ds_write_b64 v37, v[38:39]
    s_waitcnt lgkmcnt(1)
    v_add_f32 v192, v192, v193
    v_add_f32 v194, v194, v195
    v_add_f32 v192, v192, v194
    ds_write_b32 v36, v192
    s_mov_b64 exec, 1
    ds_add_u32 v6, v7 offset:96
    s_mov_b64 exec, -1
    v_lshrrev_b32 v36, 1, v1
    v_and_b32 v37, 1, v1
    v_lshlrev_b32 v43, 4, v37
    v_lshl_add_u32 v43, v36, 13, v43
    s_lshl_b32 s21, s60, 5
    s_lshl_b32 s56, s52, 19
    s_add_u32 s21, s21, s56
    s_add_u32 s21, s21, 7340032
    s_add_u32 s22, s21, 262144
    v_mul_u32_u24 v37, 4608, v37
    v_lshl_add_u32 v44, v36, 4, v37
    s_lshl_b32 s55, s52, 10
    s_add_u32 s55, s55, 148448
    v_add_u32 v44, s55, v44
    s_waitcnt vmcnt(8)
    v_cmp_ne_u32 vcc, s61, v40
    s_mov_b32 s23, 0
    s_cmp_eq_u64 vcc, 0
    s_nop 2
    s_cbranch_scc0 L_NOU
    buffer_load_dwordx4 v[16:19], v43, s[12:15], s21 offen sc1
    buffer_load_dwordx4 v[20:23], v43, s[12:15], s22 offen sc1
    s_mov_b32 s23, 1
L_NOU:
    buffer_load_dword v47, v46, s[44:47], 0 offen
    s_lshr_b32 s18, s52, 1
    s_and_b32 s19, s52, 1
    s_lshl_b32 s55, s18, 16
    s_lshl_b32 s56, s19, 13
    s_add_u32 s57, s55, s56
    s_add_u32 s57, s57, 32768
    v_lshl_add_u32 v64, v1, 2, s57
    v_and_b32 v36, 31, v1
    v_lshrrev_b32 v37, 5, v1
    v_xor_b32 v65, 16, v64
    v_and_b32 v38, 15, v1
    v_xor_b32 v37, v37, v38
    v_xor_b32 v66, 32, v64
    v_lshlrev_b32 v37, 4, v37
    v_lshl_add_u32 v37, v36, 8, v37
    v_xor_b32 v67, 48, v64
    v_add_u32 v88, s57, v37
    v_add_u32 v96, s57, v13
    v_xor_b32 v68, 64, v64
    v_xor_b32 v97, 0x2000, v96
    v_xor_b32 v89, 32, v88
    v_xor_b32 v69, 80, v64
    v_xor_b32 v90, 64, v88
    v_xor_b32 v91, 96, v88
    v_xor_b32 v70, 96, v64
    v_xor_b32 v92, 128, v88
    v_xor_b32 v93, 160, v88
    v_xor_b32 v71, 112, v64
    v_xor_b32 v94, 192, v88
    v_xor_b32 v95, 224, v88
    v_xor_b32 v72, 128, v64
    s_mul_i32 s20, s18, 16640
    s_add_u32 s20, s20, 114688
    v_xor_b32 v73, 144, v64
    s_lshl_b32 s55, s18, 2
    v_add_u32 v116, s55, v6
    v_xor_b32 v74, 160, v64
    v_mov_b32 v120, 0
    v_mov_b32 v121, 0
    v_xor_b32 v75, 176, v64
    v_mov_b32 v122, 0
    v_mov_b32 v123, 0
    v_xor_b32 v76, 192, v64
    v_lshrrev_b32 v117, 2, v1
    v_mul_u32_u24 v117, 4160, v117
    v_xor_b32 v77, 208, v64
    v_and_b32 v38, 3, v1
    v_lshl_add_u32 v117, v38, 4, v117
    v_xor_b32 v78, 224, v64
    v_add_u32 v117, s20, v117
    s_mul_i32 s55, s18, 4608
    v_xor_b32 v79, 240, v64
    s_add_u32 s55, s55, 147968
    v_add_u32 v118, s55, v13
    s_add_u32 s55, s20, 1008
    v_sub_u32 v119, s55, v13
    v_and_b32 v39, 1, v1
    v_cmp_eq_u32 s[24:25], 1, v39
    s_mov_b32 s62, 0x1000000
    s_nop 3
    s_branch L_WD7a_R
L_WD7a:
    s_sleep 1
L_WD7a_R:
    ds_read_b32 v39, v6 offset:156
    s_waitcnt lgkmcnt(0)
    v_readfirstlane_b32 s55, v39
    s_sub_u32 s62, s62, 1
    s_cselect_b32 s55, 4, s55
    s_cmp_lt_u32 s55, 4
    s_cbranch_scc1 L_WD7a
    s_setprio 3
    ds_write2st64_b32 v64, v128, v144 offset0:0 offset1:16
    ds_write2st64_b32 v65, v129, v145 offset0:1 offset1:17
    ds_write2st64_b32 v66, v130, v146 offset0:2 offset1:18
    ds_write2st64_b32 v67, v131, v147 offset0:3 offset1:19
    ds_write2st64_b32 v68, v132, v148 offset0:4 offset1:20
    ds_write2st64_b32 v69, v133, v149 offset0:5 offset1:21
    ds_write2st64_b32 v70, v134, v150 offset0:6 offset1:22
    ds_write2st64_b32 v71, v135, v151 offset0:7 offset1:23
    ds_write2st64_b32 v72, v136, v152 offset0:8 offset1:24
    ds_write2st64_b32 v73, v137, v153 offset0:9 offset1:25
    ds_write2st64_b32 v74, v138, v154 offset0:10 offset1:26
    ds_write2st64_b32 v75, v139, v155 offset0:11 offset1:27
    ds_write2st64_b32 v76, v140, v156 offset0:12 offset1:28
    ds_write2st64_b32 v77, v141, v157 offset0:13 offset1:29
    ds_write2st64_b32 v78, v142, v158 offset0:14 offset1:30
    ds_write2st64_b32 v79, v143, v159 offset0:15 offset1:31
    ds_read_b128 v[128:131], v88
    ds_read_b128 v[132:135], v89
    ds_read_b128 v[136:139], v90
    ds_read_b128 v[140:143], v91
    ds_read_b128 v[144:147], v92
    ds_read_b128 v[148:151], v93
    ds_read_b128 v[152:155], v94
    ds_read_b128 v[156:159], v95
    ds_write2st64_b32 v64, v160, v176 offset0:0 offset1:16
    ds_write2st64_b32 v65, v161, v177 offset0:1 offset1:17
    ds_write2st64_b32 v66, v162, v178 offset0:2 offset1:18
    ds_write2st64_b32 v67, v163, v179 offset0:3 offset1:19
    ds_write2st64_b32 v68, v164, v180 offset0:4 offset1:20
    ds_write2st64_b32 v69, v165, v181 offset0:5 offset1:21
    ds_write2st64_b32 v70, v166, v182 offset0:6 offset1:22
    ds_write2st64_b32 v71, v167, v183 offset0:7 offset1:23
    ds_write2st64_b32 v72, v168, v184 offset0:8 offset1:24
    ds_write2st64_b32 v73, v169, v185 offset0:9 offset1:25
    ds_write2st64_b32 v74, v170, v186 offset0:10 offset1:26
    ds_write2st64_b32 v75, v171, v187 offset0:11 offset1:27
    ds_write2st64_b32 v76, v172, v188 offset0:12 offset1:28
    ds_write2st64_b32 v77, v173, v189 offset0:13 offset1:29
    ds_write2st64_b32 v78, v174, v190 offset0:14 offset1:30
    ds_write2st64_b32 v79, v175, v191 offset0:15 offset1:31
    ds_read_b128 v[160:163], v88
    ds_read_b128 v[164:167], v89
    ds_read_b128 v[168:171], v90
    ds_read_b128 v[172:175], v91
    ds_read_b128 v[176:179], v92
    ds_read_b128 v[180:183], v93
    ds_read_b128 v[184:187], v94
    ds_read_b128 v[188:191], v95
    s_waitcnt lgkmcnt(7)
    v_mfma_f32_32x32x16_f16 v[232:247], v[160:163], v[128:131], 0
    s_waitcnt lgkmcnt(6)
    v_mfma_f32_32x32x16_f16 v[232:247], v[164:167], v[132:135], v[232:247]
    s_waitcnt lgkmcnt(5)
    v_mfma_f32_32x32x16_f16 v[232:247], v[168:171], v[136:139], v[232:247]
    s_waitcnt lgkmcnt(4)
    v_mfma_f32_32x32x16_f16 v[232:247], v[172:175], v[140:143], v[232:247]
    s_waitcnt lgkmcnt(3)
    v_mfma_f32_32x32x16_f16 v[232:247], v[176:179], v[144:147], v[232:247]
    s_waitcnt lgkmcnt(2)
    v_mfma_f32_32x32x16_f16 v[232:247], v[180:183], v[148:151], v[232:247]
    s_waitcnt lgkmcnt(1)
    v_mfma_f32_32x32x16_f16 v[232:247], v[184:187], v[152:155], v[232:247]
    s_waitcnt lgkmcnt(0)
    v_mfma_f32_32x32x16_f16 v[232:247], v[188:191], v[156:159], v[232:247]
    ds_write_b32 v116, v114 offset:40
    s_mov_b64 exec, 0xffff
    ds_write_b128 v117, v[120:123] offset:4096
    s_mov_b64 exec, 0x3fffffff
    ds_write_b128 v118, v[120:123]
    s_mov_b64 exec, -1
    s_nop 5
    ds_write_b128 v96, v[232:235] offset:0
    ds_write_b128 v96, v[236:239] offset:1024
    ds_write_b128 v96, v[240:243] offset:2048
    ds_write_b128 v96, v[244:247] offset:3072
    s_mov_b64 exec, 1
    ds_add_u32 v116, v7 offset:56
    s_mov_b64 exec, -1
    s_waitcnt vmcnt(1)
    s_cmp_eq_u32 s23, 1
    s_cbranch_scc1 L_UOK
    s_mov_b32 s62, 0x80000
L_P1:
    buffer_load_dword v40, v41, s[12:15], s16 offen sc1
    s_waitcnt vmcnt(0)
L_P1_C:
    v_cmp_ne_u32 vcc, s61, v40
    s_nop 0
    s_cmp_eq_u64 vcc, 0
    s_cbranch_scc1 L_P1_D
    s_sub_u32 s62, s62, 1
    s_cbranch_scc1 L_P1_D
    s_sleep 8
    s_branch L_P1
L_P1_D:
    buffer_load_dwordx4 v[16:19], v43, s[12:15], s21 offen sc1
    buffer_load_dwordx4 v[20:23], v43, s[12:15], s22 offen sc1
    s_waitcnt vmcnt(0)
L_UOK:
    ds_write_b128 v44, v[16:19]
    ds_write_b128 v44, v[20:23] offset:512
    s_mov_b32 s62, 0x1000000
L_WKG:
    ds_read_b32 v39, v116 offset:56
    s_waitcnt lgkmcnt(0)
    v_readfirstlane_b32 s55, v39
    s_sub_u32 s62, s62, 1
    s_cselect_b32 s55, 2, s55
    s_cmp_lt_u32 s55, 2
    s_cbranch_scc1 L_WKG
    ds_read_b128 v[128:131], v97 offset:0
    ds_read_b128 v[132:135], v97 offset:1024
    ds_read_b128 v[136:139], v97 offset:2048
    ds_read_b128 v[140:143], v97 offset:3072
    s_cmp_eq_u32 s19, 1
    s_waitcnt lgkmcnt(0)
    s_cbranch_scc1 L_KH1
    v_add_f32 v232, v232, v128
    v_add_f32 v233, v233, v129
    v_add_f32 v234, v234, v130
    v_add_f32 v235, v235, v131
    v_add_f32 v236, v236, v132
    v_add_f32 v237, v237, v133
    v_add_f32 v238, v238, v134
    v_add_f32 v239, v239, v135
    v_add_f32 v240, v240, v136
    v_add_f32 v241, v241, v137
    v_add_f32 v242, v242, v138
    v_mov_b32 v160, 0
    v_mov_b32 v161, 0
    v_cvt_pk_f16_f32 v164, v239, v238
    v_cvt_pk_f16_f32 v165, v237, v236
    v_cvt_pk_f16_f32 v166, v235, v234
    v_cvt_pk_f16_f32 v167, v233, v232
    v_cvt_pk_f16_f32 v188, v242, v242
    v_cvt_pk_f16_f32 v189, v241, v241
    v_cvt_pk_f16_f32 v190, v241, v240
    v_cvt_pk_f16_f32 v191, v240, v240
    ds_write_b128 v119, v[164:167] offset:3072
    v_mov_b32_dpp v168, v160 wave_ror:1 row_mask:0xf bank_mask:0xf
    v_mov_b32_dpp v169, v161 wave_ror:1 row_mask:0xf bank_mask:0xf
    s_nop 0
    v_mov_b32_dpp v168, v164 wave_shr:1 row_mask:0xf bank_mask:0xf
    v_mov_b32_dpp v169, v165 wave_shr:1 row_mask:0xf bank_mask:0xf
    v_alignbit_b32 v172, v165, v164, 16
    v_alignbit_b32 v173, v166, v165, 16
    v_alignbit_b32 v174, v167, v166, 16
    v_alignbit_b32 v175, v168, v167, 16
    ds_write_b128 v119, v[172:175] offset:7232
    v_mov_b32 v176, v165
    v_mov_b32 v177, v166
    v_mov_b32 v178, v167
    v_mov_b32 v179, v168
    ds_write_b128 v119, v[176:179] offset:11392
    v_alignbit_b32 v180, v166, v165, 16
    v_alignbit_b32 v181, v167, v166, 16
    v_alignbit_b32 v182, v168, v167, 16
    v_alignbit_b32 v183, v169, v168, 16
    ds_write_b128 v119, v[180:183] offset:15552
    ds_write_b128 v119, v[188:191] offset:2048
    v_mov_b32_dpp v192, v164 wave_ror:1 row_mask:0xf bank_mask:0xf
    v_mov_b32_dpp v193, v165 wave_ror:1 row_mask:0xf bank_mask:0xf
    s_nop 0
    v_mov_b32_dpp v192, v188 wave_shr:1 row_mask:0xf bank_mask:0xf
    v_mov_b32_dpp v193, v189 wave_shr:1 row_mask:0xf bank_mask:0xf
    v_alignbit_b32 v196, v189, v188, 16
    v_alignbit_b32 v197, v190, v189, 16
    v_alignbit_b32 v198, v191, v190, 16
    v_alignbit_b32 v199, v192, v191, 16
    ds_write_b128 v119, v[196:199] offset:6208
    v_mov_b32 v200, v189
    v_mov_b32 v201, v190
    v_mov_b32 v202, v191
    v_mov_b32 v203, v192
    ds_write_b128 v119, v[200:203] offset:10368
    v_alignbit_b32 v204, v190, v189, 16
    v_alignbit_b32 v205, v191, v190, 16
    v_alignbit_b32 v206, v192, v191, 16
    v_alignbit_b32 v207, v193, v192, 16
    ds_write_b128 v119, v[204:207] offset:14528
    s_nop 1
    s_branch L_KH2
L_KH1:
    v_add_f32 v241, v241, v137
    v_add_f32 v242, v242, v138
    v_add_f32 v243, v243, v139
    v_add_f32 v244, v244, v140
    v_add_f32 v245, v245, v141
    v_add_f32 v246, v246, v142
    v_cvt_pk_f16_f32 v160, v242, v242
    v_cvt_pk_f16_f32 v161, v241, v241
    v_cndmask_b32 v39, v243, v244, s[24:25]
    v_cvt_pk_f16_f32 v164, v244, v244
    v_cvt_pk_f16_f32 v165, v244, v39
    v_cvt_pk_f16_f32 v166, v243, v243
    v_cvt_pk_f16_f32 v167, v243, v243
    v_cndmask_b32 v39, v245, v246, s[24:25]
    v_cvt_pk_f16_f32 v188, v246, v246
    v_cvt_pk_f16_f32 v189, v246, v39
    v_cvt_pk_f16_f32 v190, v245, v245
    v_cvt_pk_f16_f32 v191, v245, v245
    ds_write_b128 v119, v[164:167] offset:1024
    v_mov_b32_dpp v168, v160 wave_ror:1 row_mask:0xf bank_mask:0xf
    v_mov_b32_dpp v169, v161 wave_ror:1 row_mask:0xf bank_mask:0xf
    s_nop 0
    v_mov_b32_dpp v168, v164 wave_shr:1 row_mask:0xf bank_mask:0xf
    v_mov_b32_dpp v169, v165 wave_shr:1 row_mask:0xf bank_mask:0xf
    v_alignbit_b32 v172, v165, v164, 16
    v_alignbit_b32 v173, v166, v165, 16
    v_alignbit_b32 v174, v167, v166, 16
    v_alignbit_b32 v175, v168, v167, 16
    ds_write_b128 v119, v[172:175] offset:5184
    v_mov_b32 v176, v165
    v_mov_b32 v177, v166
    v_mov_b32 v178, v167
    v_mov_b32 v179, v168
    ds_write_b128 v119, v[176:179] offset:9344
    v_alignbit_b32 v180, v166, v165, 16
    v_alignbit_b32 v181, v167, v166, 16
    v_alignbit_b32 v182, v168, v167, 16
    v_alignbit_b32 v183, v169, v168, 16
    ds_write_b128 v119, v[180:183] offset:13504
    ds_write_b128 v119, v[188:191] offset:0
    v_mov_b32_dpp v192, v164 wave_ror:1 row_mask:0xf bank_mask:0xf
    v_mov_b32_dpp v193, v165 wave_ror:1 row_mask:0xf bank_mask:0xf
    s_nop 0
    v_mov_b32_dpp v192, v188 wave_shr:1 row_mask:0xf bank_mask:0xf
    v_mov_b32_dpp v193, v189 wave_shr:1 row_mask:0xf bank_mask:0xf
    v_alignbit_b32 v196, v189, v188, 16
    v_alignbit_b32 v197, v190, v189, 16
    v_alignbit_b32 v198, v191, v190, 16
    v_alignbit_b32 v199, v192, v191, 16
    ds_write_b128 v119, v[196:199] offset:4160
    v_mov_b32 v200, v189
    v_mov_b32 v201, v190
    v_mov_b32 v202, v191
    v_mov_b32 v203, v192
    ds_write_b128 v119, v[200:203] offset:8320
    v_alignbit_b32 v204, v190, v189, 16
    v_alignbit_b32 v205, v191, v190, 16
    v_alignbit_b32 v206, v192, v191, 16
    v_alignbit_b32 v207, v193, v192, 16
    ds_write_b128 v119, v[204:207] offset:12480
    s_nop 1
L_KH2:
    s_mov_b64 exec, 1
    ds_add_u32 v6, v7 offset:0
    s_mov_b64 exec, -1
    s_setprio 0
    s_mov_b32 s62, 0x1000000
    s_branch L_WST_R
L_WST:
    s_sleep 1
L_WST_R:
    ds_read_b32 v39, v6 offset:68
    s_waitcnt lgkmcnt(0)
    v_readfirstlane_b32 s55, v39
    s_sub_u32 s62, s62, 1
    s_cselect_b32 s55, 4, s55
    s_cmp_lt_u32 s55, 4
    s_cbranch_scc1 L_WST
    s_add_u32 m0, s67, 16384
    s_lshl_b32 s28, s39, 15
    s_add_u32 s28, s31, s28
    s_add_u32 s39, s39, 1
    s_cmp_eq_u32 s39, 14
    s_cselect_b32 s39, 0, s39
    buffer_load_dwordx4 v52, s[44:47], s28 offen offset:0 lds
    buffer_load_dwordx4 v53, s[44:47], s28 offen offset:1024 lds
    buffer_load_dwordx4 v54, s[44:47], s28 offen offset:2048 lds
    buffer_load_dwordx4 v55, s[44:47], s28 offen offset:3072 lds
    s_add_u32 m0, s67, 81920
    s_lshl_b32 s28, s39, 15
    s_add_u32 s28, s31, s28
    s_add_u32 s39, s39, 1
    s_cmp_eq_u32 s39, 14
    s_cselect_b32 s39, 0, s39
    buffer_load_dwordx4 v52, s[44:47], s28 offen offset:0 lds
    buffer_load_dwordx4 v53, s[44:47], s28 offen offset:1024 lds
    buffer_load_dwordx4 v54, s[44:47], s28 offen offset:2048 lds
    buffer_load_dwordx4 v55, s[44:47], s28 offen offset:3072 lds
    s_mov_b32 s62, 0x1000000
L_WXS:
    ds_read_b32 v39, v6 offset:0
    s_waitcnt lgkmcnt(0)
    v_readfirstlane_b32 s55, v39
    s_sub_u32 s62, s62, 1
    s_cselect_b32 s55, 4, s55
    s_cmp_lt_u32 s55, 4
    s_cbranch_scc1 L_WXS
    s_add_u32 m0, s67, 32768
    s_lshl_b32 s28, s39, 15
    s_add_u32 s28, s31, s28
    s_add_u32 s39, s39, 1
    s_cmp_eq_u32 s39, 14
    s_cselect_b32 s39, 0, s39
    buffer_load_dwordx4 v52, s[44:47], s28 offen offset:0 lds
    buffer_load_dwordx4 v53, s[44:47], s28 offen offset:1024 lds
    buffer_load_dwordx4 v54, s[44:47], s28 offen offset:2048 lds
    buffer_load_dwordx4 v55, s[44:47], s28 offen offset:3072 lds
    s_add_u32 m0, s67, 98304
    s_lshl_b32 s28, s39, 15
    s_add_u32 s28, s31, s28
    s_add_u32 s39, s39, 1
    s_cmp_eq_u32 s39, 14
    s_cselect_b32 s39, 0, s39
    buffer_load_dwordx4 v52, s[44:47], s28 offen offset:0 lds
    buffer_load_dwordx4 v53, s[44:47], s28 offen offset:1024 lds
    buffer_load_dwordx4 v54, s[44:47], s28 offen offset:2048 lds
    buffer_load_dwordx4 v55, s[44:47], s28 offen offset:3072 lds
    s_lshl_b32 s69, s63, 7
    s_lshl_b32 s56, s52, 5
    s_add_u32 s69, s69, s56
    s_add_u32 s69, s69, 13651968
    v_and_b32 v36, 7, v1
    v_lshlrev_b32 v36, 2, v36
    ds_read_b64_tr_b16 v[80:81], v56 offset:0
    ds_read_b64_tr_b16 v[82:83], v56 offset:512
    ds_read_b64_tr_b16 v[84:85], v57 offset:0
    ds_read_b64_tr_b16 v[86:87], v57 offset:512
    ds_read_b64_tr_b16 v[88:89], v58 offset:0
    ds_read_b64_tr_b16 v[90:91], v58 offset:512
    ds_read_b64_tr_b16 v[92:93], v59 offset:0
    ds_read_b64_tr_b16 v[94:95], v59 offset:512
    ds_read_b64_tr_b16 v[96:97], v60 offset:0
    ds_read_b64_tr_b16 v[98:99], v60 offset:512
    ds_read_b64_tr_b16 v[100:101], v61 offset:0
    ds_read_b64_tr_b16 v[102:103], v61 offset:512
    ds_read_b64_tr_b16 v[104:105], v62 offset:0
    ds_read_b64_tr_b16 v[106:107], v62 offset:512
    ds_read_b64_tr_b16 v[108:109], v63 offset:0
    ds_read_b64_tr_b16 v[110:111], v63 offset:512
    s_waitcnt lgkmcnt(8)
    s_add_u32 m0, s67, 0
    s_lshl_b32 s28, s39, 15
    s_add_u32 s28, s31, s28
    s_add_u32 s39, s39, 1
    s_cmp_eq_u32 s39, 14
    s_cselect_b32 s39, 0, s39
    buffer_load_dwordx4 v52, s[44:47], s28 offen offset:0 lds
    buffer_load_dwordx4 v53, s[44:47], s28 offen offset:1024 lds
    buffer_load_dwordx4 v54, s[44:47], s28 offen offset:2048 lds
    buffer_load_dwordx4 v55, s[44:47], s28 offen offset:3072 lds
    s_waitcnt vmcnt(16)
    ds_read_b64_tr_b16 v[112:113], v56 offset:16384
    ds_read_b64_tr_b16 v[114:115], v56 offset:16896
    ds_read_b64_tr_b16 v[116:117], v57 offset:16384
    ds_read_b64_tr_b16 v[118:119], v57 offset:16896
    ds_read_b64_tr_b16 v[120:121], v58 offset:16384
    ds_read_b64_tr_b16 v[122:123], v58 offset:16896
    ds_read_b64_tr_b16 v[124:125], v59 offset:16384
    ds_read_b64_tr_b16 v[126:127], v59 offset:16896
    s_waitcnt lgkmcnt(8)
    s_add_u32 m0, s67, 65536
    s_lshl_b32 s28, s39, 15
    s_add_u32 s28, s31, s28
    s_add_u32 s39, s39, 1
    s_cmp_eq_u32 s39, 14
    s_cselect_b32 s39, 0, s39
    buffer_load_dwordx4 v52, s[44:47], s28 offen offset:0 lds
    buffer_load_dwordx4 v53, s[44:47], s28 offen offset:1024 lds
    buffer_load_dwordx4 v54, s[44:47], s28 offen offset:2048 lds
    buffer_load_dwordx4 v55, s[44:47], s28 offen offset:3072 lds
    s_waitcnt vmcnt(16)
    ds_read_b64_tr_b16 v[128:129], v60 offset:16384
    ds_read_b64_tr_b16 v[130:131], v60 offset:16896
    ds_read_b64_tr_b16 v[132:133], v61 offset:16384
    ds_read_b64_tr_b16 v[134:135], v61 offset:16896
    ds_read_b64_tr_b16 v[136:137], v62 offset:16384
    ds_read_b64_tr_b16 v[138:139], v62 offset:16896
    ds_read_b64_tr_b16 v[140:141], v63 offset:16384
    ds_read_b64_tr_b16 v[142:143], v63 offset:16896
    s_waitcnt lgkmcnt(8)
    s_add_u32 m0, s67, 16384
    s_lshl_b32 s28, s39, 15
    s_add_u32 s28, s31, s28
    s_add_u32 s39, s39, 1
    s_cmp_eq_u32 s39, 14
    s_cselect_b32 s39, 0, s39
    buffer_load_dwordx4 v52, s[44:47], s28 offen offset:0 lds
    buffer_load_dwordx4 v53, s[44:47], s28 offen offset:1024 lds
    buffer_load_dwordx4 v54, s[44:47], s28 offen offset:2048 lds
    buffer_load_dwordx4 v55, s[44:47], s28 offen offset:3072 lds
    s_waitcnt vmcnt(16)
    ds_read_b64_tr_b16 v[144:145], v56 offset:32768
    ds_read_b64_tr_b16 v[146:147], v56 offset:33280
    ds_read_b64_tr_b16 v[148:149], v57 offset:32768
    ds_read_b64_tr_b16 v[150:151], v57 offset:33280
    ds_read_b64_tr_b16 v[152:153], v58 offset:32768
    ds_read_b64_tr_b16 v[154:155], v58 offset:33280
    ds_read_b64_tr_b16 v[156:157], v59 offset:32768
    ds_read_b64_tr_b16 v[158:159], v59 offset:33280
    s_waitcnt lgkmcnt(8)
    s_add_u32 m0, s67, 81920
    s_lshl_b32 s28, s39, 15
    s_add_u32 s28, s31, s28
    s_add_u32 s39, s39, 1
    s_cmp_eq_u32 s39, 14
    s_cselect_b32 s39, 0, s39
    buffer_load_dwordx4 v52, s[44:47], s28 offen offset:0 lds
    buffer_load_dwordx4 v53, s[44:47], s28 offen offset:1024 lds
    buffer_load_dwordx4 v54, s[44:47], s28 offen offset:2048 lds
    buffer_load_dwordx4 v55, s[44:47], s28 offen offset:3072 lds
    s_waitcnt vmcnt(16)
    ds_read_b64_tr_b16 v[160:161], v60 offset:32768
    ds_read_b64_tr_b16 v[162:163], v60 offset:33280
    ds_read_b64_tr_b16 v[164:165], v61 offset:32768
    ds_read_b64_tr_b16 v[166:167], v61 offset:33280
    ds_read_b64_tr_b16 v[168:169], v62 offset:32768
    ds_read_b64_tr_b16 v[170:171], v62 offset:33280
    ds_read_b64_tr_b16 v[172:173], v63 offset:32768
    ds_read_b64_tr_b16 v[174:175], v63 offset:33280
    s_waitcnt lgkmcnt(8)
    s_add_u32 m0, s67, 32768
    s_lshl_b32 s28, s39, 15
    s_add_u32 s28, s31, s28
    s_add_u32 s39, s39, 1
    s_cmp_eq_u32 s39, 14
    s_cselect_b32 s39, 0, s39
    buffer_load_dwordx4 v52, s[44:47], s28 offen offset:0 lds
    buffer_load_dwordx4 v53, s[44:47], s28 offen offset:1024 lds
    buffer_load_dwordx4 v54, s[44:47], s28 offen offset:2048 lds
    buffer_load_dwordx4 v55, s[44:47], s28 offen offset:3072 lds
    s_waitcnt vmcnt(16)
    ds_read_b64_tr_b16 v[176:177], v56 offset:0
    ds_read_b64_tr_b16 v[178:179], v56 offset:512
    ds_read_b64_tr_b16 v[180:181], v57 offset:0
    ds_read_b64_tr_b16 v[182:183], v57 offset:512
    ds_read_b64_tr_b16 v[184:185], v58 offset:0
    ds_read_b64_tr_b16 v[186:187], v58 offset:512
    ds_read_b64_tr_b16 v[188:189], v59 offset:0
    ds_read_b64_tr_b16 v[190:191], v59 offset:512
    s_waitcnt lgkmcnt(8)
    s_add_u32 m0, s67, 98304
    s_lshl_b32 s28, s39, 15
    s_add_u32 s28, s31, s28
    s_add_u32 s39, s39, 1
    s_cmp_eq_u32 s39, 14
    s_cselect_b32 s39, 0, s39
    buffer_load_dwordx4 v52, s[44:47], s28 offen offset:0 lds
    buffer_load_dwordx4 v53, s[44:47], s28 offen offset:1024 lds
    buffer_load_dwordx4 v54, s[44:47], s28 offen offset:2048 lds
    buffer_load_dwordx4 v55, s[44:47], s28 offen offset:3072 lds
    s_waitcnt lgkmcnt(0)
    buffer_load_dword v38, v36, s[12:15], s69 offen sc1
    s_add_u32 m0, s67, 0
    s_lshl_b32 s28, s39, 15
    s_add_u32 s28, s31, s28
    s_add_u32 s39, s39, 1
    s_cmp_eq_u32 s39, 14
    s_cselect_b32 s39, 0, s39
    buffer_load_dwordx4 v52, s[44:47], s28 offen offset:0 lds
    buffer_load_dwordx4 v53, s[44:47], s28 offen offset:1024 lds
    buffer_load_dwordx4 v54, s[44:47], s28 offen offset:2048 lds
    buffer_load_dwordx4 v55, s[44:47], s28 offen offset:3072 lds
    v_lshrrev_b32 v2, 3, v0
    v_and_b32 v3, 7, v0
    v_lshlrev_b32 v3, 4, v3
    v_lshl_add_u32 v12, v2, 10, v3
    s_lshl_b32 s55, s63, 16
    s_lshl_b32 s56, s64, 7
    s_add_u32 s55, s55, s56
    v_add_u32 v12, s55, v12
    buffer_load_dwordx4 v[8:11], v12, s[4:7], 0 offen
    s_mov_b32 s62, 0x80000
    s_waitcnt vmcnt(5)
    s_branch L_P2_C
L_P2:
    buffer_load_dword v38, v36, s[12:15], s69 offen sc1
    s_waitcnt vmcnt(0)
L_P2_C:
    v_cmp_ne_u32 vcc, s61, v38
    s_nop 0
    s_cmp_eq_u64 vcc, 0
    s_cbranch_scc1 L_P2_D
    s_sub_u32 s62, s62, 1
    s_cbranch_scc1 L_P2_D
    s_sleep 4
    s_branch L_P2
L_P2_D:
    s_lshl_b32 s29, s38, 10
    s_add_u32 s29, s30, s29
    s_add_u32 s38, s38, 1
    s_cmp_eq_u32 s38, 14
    s_cselect_b32 s38, 0, s38
    buffer_load_dwordx4 v[16:19], v48, s[12:15], s29 offen sc1
    buffer_load_dwordx4 v[20:23], v49, s[12:15], s29 offen sc1
    buffer_load_dwordx4 v[24:27], v50, s[12:15], s29 offen sc1
    buffer_load_dwordx4 v[28:31], v51, s[12:15], s29 offen sc1
    s_lshl_b32 s29, s38, 10
    s_add_u32 s29, s30, s29
    s_add_u32 s38, s38, 1
    s_cmp_eq_u32 s38, 14
    s_cselect_b32 s38, 0, s38
    buffer_load_dwordx4 v[32:35], v48, s[12:15], s29 offen sc1
    buffer_load_dwordx4 v[36:39], v49, s[12:15], s29 offen sc1
    buffer_load_dwordx4 v[40:43], v50, s[12:15], s29 offen sc1
    buffer_load_dwordx4 v[44:47], v51, s[12:15], s29 offen sc1
    s_lshl_b32 s29, s38, 10
    s_add_u32 s29, s30, s29
    s_add_u32 s38, s38, 1
    s_cmp_eq_u32 s38, 14
    s_cselect_b32 s38, 0, s38
    buffer_load_dwordx4 v[64:67], v48, s[12:15], s29 offen sc1
    buffer_load_dwordx4 v[68:71], v49, s[12:15], s29 offen sc1
    buffer_load_dwordx4 v[72:75], v50, s[12:15], s29 offen sc1
    buffer_load_dwordx4 v[76:79], v51, s[12:15], s29 offen sc1
    v_bfe_u32 v2, v0, 3, 4
    v_and_b32 v13, 7, v0
    v_lshlrev_b32 v3, 1, v13
    v_xor_b32 v3, v3, v2
    v_lshlrev_b32 v3, 4, v3
    v_lshl_add_u32 v14, v2, 8, v3
    v_lshrrev_b32 v2, 7, v0
    v_lshl_add_u32 v14, v2, 14, v14
    v_xor_b32 v15, 16, v14
    v_bfe_u32 v3, v0, 5, 3
    v_xor_b32 v13, v13, v3
    v_lshlrev_b32 v13, 4, v13
    v_lshrrev_b32 v2, 3, v0
    v_lshl_add_u32 v13, v2, 7, v13
    v_add_u32 v13, 147968, v13
    v_and_b32 v2, 15, v1
    v_lshrrev_b32 v3, 4, v1
    v_xor_b32 v3, v3, v2
    v_lshlrev_b32 v3, 4, v3
    v_lshl_add_u32 v2, v2, 8, v3
    v_add_u32 v2, s67, v2
    v_xor_b32 v3, 64, v2
    v_xor_b32 v4, 128, v2
    v_xor_b32 v5, 192, v2
    s_waitcnt vmcnt(8)
    v_mfma_f32_16x16x32_bf16 v[192:195], v[80:83], v[16:19], 0
    v_mfma_f32_16x16x32_bf16 v[196:199], v[80:83], v[20:23], 0
    v_mfma_f32_16x16x32_bf16 v[200:203], v[80:83], v[24:27], 0
    v_mfma_f32_16x16x32_bf16 v[204:207], v[80:83], v[28:31], 0
    v_mfma_f32_16x16x32_bf16 v[208:211], v[84:87], v[16:19], 0
    v_mfma_f32_16x16x32_bf16 v[212:215], v[84:87], v[20:23], 0
    v_mfma_f32_16x16x32_bf16 v[216:219], v[84:87], v[24:27], 0
    v_mfma_f32_16x16x32_bf16 v[220:223], v[84:87], v[28:31], 0
    v_mfma_f32_16x16x32_bf16 v[224:227], v[88:91], v[16:19], 0
    v_mfma_f32_16x16x32_bf16 v[228:231], v[88:91], v[20:23], 0
    v_mfma_f32_16x16x32_bf16 v[232:235], v[88:91], v[24:27], 0
    v_mfma_f32_16x16x32_bf16 v[236:239], v[88:91], v[28:31], 0
    v_mfma_f32_16x16x32_bf16 v[240:243], v[92:95], v[16:19], 0
    v_mfma_f32_16x16x32_bf16 v[244:247], v[92:95], v[20:23], 0
    v_mfma_f32_16x16x32_bf16 v[248:251], v[92:95], v[24:27], 0
    v_mfma_f32_16x16x32_bf16 v[252:255], v[92:95], v[28:31], 0
    s_waitcnt vmcnt(4)
    v_mfma_f32_16x16x32_bf16 v[192:195], v[96:99], v[32:35], v[192:195]
    s_lshl_b32 s29, s38, 10
    s_add_u32 s29, s30, s29
    s_add_u32 s38, s38, 1
    s_cmp_eq_u32 s38, 14
    s_cselect_b32 s38, 0, s38
    buffer_load_dwordx4 v[16:19], v48, s[12:15], s29 offen sc1
    buffer_load_dwordx4 v[20:23], v49, s[12:15], s29 offen sc1
    buffer_load_dwordx4 v[24:27], v50, s[12:15], s29 offen sc1
    buffer_load_dwordx4 v[28:31], v51, s[12:15], s29 offen sc1
    v_mfma_f32_16x16x32_bf16 v[196:199], v[96:99], v[36:39], v[196:199]
    v_mfma_f32_16x16x32_bf16 v[200:203], v[96:99], v[40:43], v[200:203]
    v_mfma_f32_16x16x32_bf16 v[204:207], v[96:99], v[44:47], v[204:207]
    v_mfma_f32_16x16x32_bf16 v[208:211], v[100:103], v[32:35], v[208:211]
    v_mfma_f32_16x16x32_bf16 v[212:215], v[100:103], v[36:39], v[212:215]
    v_mfma_f32_16x16x32_bf16 v[216:219], v[100:103], v[40:43], v[216:219]
    v_mfma_f32_16x16x32_bf16 v[220:223], v[100:103], v[44:47], v[220:223]
    v_mfma_f32_16x16x32_bf16 v[224:227], v[104:107], v[32:35], v[224:227]
    s_lshl_b32 s29, s38, 10
    s_add_u32 s29, s30, s29
    s_add_u32 s38, s38, 1
    s_cmp_eq_u32 s38, 14
    s_cselect_b32 s38, 0, s38
    buffer_load_dwordx4 v[80:83], v48, s[12:15], s29 offen sc1
    buffer_load_dwordx4 v[84:87], v49, s[12:15], s29 offen sc1
    buffer_load_dwordx4 v[88:91], v50, s[12:15], s29 offen sc1
    buffer_load_dwordx4 v[92:95], v51, s[12:15], s29 offen sc1
    v_mfma_f32_16x16x32_bf16 v[228:231], v[104:107], v[36:39], v[228:231]
    v_mfma_f32_16x16x32_bf16 v[232:235], v[104:107], v[40:43], v[232:235]
    v_mfma_f32_16x16x32_bf16 v[236:239], v[104:107], v[44:47], v[236:239]
    v_mfma_f32_16x16x32_bf16 v[240:243], v[108:111], v[32:35], v[240:243]
    v_mfma_f32_16x16x32_bf16 v[244:247], v[108:111], v[36:39], v[244:247]
    v_mfma_f32_16x16x32_bf16 v[248:251], v[108:111], v[40:43], v[248:251]
    v_mfma_f32_16x16x32_bf16 v[252:255], v[108:111], v[44:47], v[252:255]
    s_waitcnt vmcnt(8)
    v_mfma_f32_16x16x32_bf16 v[192:195], v[112:115], v[64:67], v[192:195]
    s_lshl_b32 s29, s38, 10
    s_add_u32 s29, s30, s29
    s_add_u32 s38, s38, 1
    s_cmp_eq_u32 s38, 14
    s_cselect_b32 s38, 0, s38
    buffer_load_dwordx4 v[32:35], v48, s[12:15], s29 offen sc1
    buffer_load_dwordx4 v[36:39], v49, s[12:15], s29 offen sc1
    buffer_load_dwordx4 v[40:43], v50, s[12:15], s29 offen sc1
    buffer_load_dwordx4 v[44:47], v51, s[12:15], s29 offen sc1
    v_mfma_f32_16x16x32_bf16 v[196:199], v[112:115], v[68:71], v[196:199]
    v_mfma_f32_16x16x32_bf16 v[200:203], v[112:115], v[72:75], v[200:203]
    v_mfma_f32_16x16x32_bf16 v[204:207], v[112:115], v[76:79], v[204:207]
    v_mfma_f32_16x16x32_bf16 v[208:211], v[116:119], v[64:67], v[208:211]
    v_mfma_f32_16x16x32_bf16 v[212:215], v[116:119], v[68:71], v[212:215]
    v_mfma_f32_16x16x32_bf16 v[216:219], v[116:119], v[72:75], v[216:219]
    v_mfma_f32_16x16x32_bf16 v[220:223], v[116:119], v[76:79], v[220:223]
    v_mfma_f32_16x16x32_bf16 v[224:227], v[120:123], v[64:67], v[224:227]
    s_lshl_b32 s29, s38, 10
    s_add_u32 s29, s30, s29
    s_add_u32 s38, s38, 1
    s_cmp_eq_u32 s38, 14
    s_cselect_b32 s38, 0, s38
    buffer_load_dwordx4 v[96:99], v48, s[12:15], s29 offen sc1
    buffer_load_dwordx4 v[100:103], v49, s[12:15], s29 offen sc1
    buffer_load_dwordx4 v[104:107], v50, s[12:15], s29 offen sc1
    buffer_load_dwordx4 v[108:111], v51, s[12:15], s29 offen sc1
    v_mfma_f32_16x16x32_bf16 v[228:231], v[120:123], v[68:71], v[228:231]
    v_mfma_f32_16x16x32_bf16 v[232:235], v[120:123], v[72:75], v[232:235]
    v_mfma_f32_16x16x32_bf16 v[236:239], v[120:123], v[76:79], v[236:239]
    v_mfma_f32_16x16x32_bf16 v[240:243], v[124:127], v[64:67], v[240:243]
    v_mfma_f32_16x16x32_bf16 v[244:247], v[124:127], v[68:71], v[244:247]
    v_mfma_f32_16x16x32_bf16 v[248:251], v[124:127], v[72:75], v[248:251]
    v_mfma_f32_16x16x32_bf16 v[252:255], v[124:127], v[76:79], v[252:255]
    s_waitcnt vmcnt(12)
    v_mfma_f32_16x16x32_bf16 v[192:195], v[128:131], v[16:19], v[192:195]
    s_lshl_b32 s29, s38, 10
    s_add_u32 s29, s30, s29
    s_add_u32 s38, s38, 1
    s_cmp_eq_u32 s38, 14
    s_cselect_b32 s38, 0, s38
    buffer_load_dwordx4 v[64:67], v48, s[12:15], s29 offen sc1
    buffer_load_dwordx4 v[68:71], v49, s[12:15], s29 offen sc1
    v_mfma_f32_16x16x32_bf16 v[196:199], v[128:131], v[20:23], v[196:199]
    v_mfma_f32_16x16x32_bf16 v[200:203], v[128:131], v[24:27], v[200:203]
    v_mfma_f32_16x16x32_bf16 v[204:207], v[128:131], v[28:31], v[204:207]
    v_mfma_f32_16x16x32_bf16 v[208:211], v[132:135], v[16:19], v[208:211]
    v_mfma_f32_16x16x32_bf16 v[212:215], v[132:135], v[20:23], v[212:215]
    v_mfma_f32_16x16x32_bf16 v[216:219], v[132:135], v[24:27], v[216:219]
    v_mfma_f32_16x16x32_bf16 v[220:223], v[132:135], v[28:31], v[220:223]
    v_mfma_f32_16x16x32_bf16 v[224:227], v[136:139], v[16:19], v[224:227]
    buffer_load_dwordx4 v[72:75], v50, s[12:15], s29 offen sc1
    buffer_load_dwordx4 v[76:79], v51, s[12:15], s29 offen sc1
    v_mfma_f32_16x16x32_bf16 v[228:231], v[136:139], v[20:23], v[228:231]
    v_mfma_f32_16x16x32_bf16 v[232:235], v[136:139], v[24:27], v[232:235]
    v_mfma_f32_16x16x32_bf16 v[236:239], v[136:139], v[28:31], v[236:239]
    v_mfma_f32_16x16x32_bf16 v[240:243], v[140:143], v[16:19], v[240:243]
    v_mfma_f32_16x16x32_bf16 v[244:247], v[140:143], v[20:23], v[244:247]
    v_mfma_f32_16x16x32_bf16 v[248:251], v[140:143], v[24:27], v[248:251]
    v_mfma_f32_16x16x32_bf16 v[252:255], v[140:143], v[28:31], v[252:255]
    s_waitcnt vmcnt(12)
    v_mfma_f32_16x16x32_bf16 v[192:195], v[144:147], v[80:83], v[192:195]
    s_lshl_b32 s29, s38, 10
    s_add_u32 s29, s30, s29
    s_add_u32 s38, s38, 1
    s_cmp_eq_u32 s38, 14
    s_cselect_b32 s38, 0, s38
    buffer_load_dwordx4 v[112:115], v48, s[12:15], s29 offen sc1
    buffer_load_dwordx4 v[116:119], v49, s[12:15], s29 offen sc1
    v_mfma_f32_16x16x32_bf16 v[196:199], v[144:147], v[84:87], v[196:199]
    v_mfma_f32_16x16x32_bf16 v[200:203], v[144:147], v[88:91], v[200:203]
    v_mfma_f32_16x16x32_bf16 v[204:207], v[144:147], v[92:95], v[204:207]
    v_mfma_f32_16x16x32_bf16 v[208:211], v[148:151], v[80:83], v[208:211]
    v_mfma_f32_16x16x32_bf16 v[212:215], v[148:151], v[84:87], v[212:215]
    v_mfma_f32_16x16x32_bf16 v[216:219], v[148:151], v[88:91], v[216:219]
    v_mfma_f32_16x16x32_bf16 v[220:223], v[148:151], v[92:95], v[220:223]
    v_mfma_f32_16x16x32_bf16 v[224:227], v[152:155], v[80:83], v[224:227]
    buffer_load_dwordx4 v[120:123], v50, s[12:15], s29 offen sc1
    buffer_load_dwordx4 v[124:127], v51, s[12:15], s29 offen sc1
    v_mfma_f32_16x16x32_bf16 v[228:231], v[152:155], v[84:87], v[228:231]
    v_mfma_f32_16x16x32_bf16 v[232:235], v[152:155], v[88:91], v[232:235]
    v_mfma_f32_16x16x32_bf16 v[236:239], v[152:155], v[92:95], v[236:239]
    v_mfma_f32_16x16x32_bf16 v[240:243], v[156:159], v[80:83], v[240:243]
    v_mfma_f32_16x16x32_bf16 v[244:247], v[156:159], v[84:87], v[244:247]
    v_mfma_f32_16x16x32_bf16 v[248:251], v[156:159], v[88:91], v[248:251]
    v_mfma_f32_16x16x32_bf16 v[252:255], v[156:159], v[92:95], v[252:255]
    s_waitcnt vmcnt(12)
    v_mfma_f32_16x16x32_bf16 v[192:195], v[160:163], v[32:35], v[192:195]
    s_lshl_b32 s29, s38, 10
    s_add_u32 s29, s30, s29
    s_add_u32 s38, s38, 1
    s_cmp_eq_u32 s38, 14
    s_cselect_b32 s38, 0, s38
    buffer_load_dwordx4 v[16:19], v48, s[12:15], s29 offen sc1
    buffer_load_dwordx4 v[20:23], v49, s[12:15], s29 offen sc1
    v_mfma_f32_16x16x32_bf16 v[196:199], v[160:163], v[36:39], v[196:199]
    v_mfma_f32_16x16x32_bf16 v[200:203], v[160:163], v[40:43], v[200:203]
    v_mfma_f32_16x16x32_bf16 v[204:207], v[160:163], v[44:47], v[204:207]
    v_mfma_f32_16x16x32_bf16 v[208:211], v[164:167], v[32:35], v[208:211]
    v_mfma_f32_16x16x32_bf16 v[212:215], v[164:167], v[36:39], v[212:215]
    v_mfma_f32_16x16x32_bf16 v[216:219], v[164:167], v[40:43], v[216:219]
    v_mfma_f32_16x16x32_bf16 v[220:223], v[164:167], v[44:47], v[220:223]
    v_mfma_f32_16x16x32_bf16 v[224:227], v[168:171], v[32:35], v[224:227]
    buffer_load_dwordx4 v[24:27], v50, s[12:15], s29 offen sc1
    buffer_load_dwordx4 v[28:31], v51, s[12:15], s29 offen sc1
    v_mfma_f32_16x16x32_bf16 v[228:231], v[168:171], v[36:39], v[228:231]
    v_mfma_f32_16x16x32_bf16 v[232:235], v[168:171], v[40:43], v[232:235]
    v_mfma_f32_16x16x32_bf16 v[236:239], v[168:171], v[44:47], v[236:239]
    v_mfma_f32_16x16x32_bf16 v[240:243], v[172:175], v[32:35], v[240:243]
    v_mfma_f32_16x16x32_bf16 v[244:247], v[172:175], v[36:39], v[244:247]
    v_mfma_f32_16x16x32_bf16 v[248:251], v[172:175], v[40:43], v[248:251]
    v_mfma_f32_16x16x32_bf16 v[252:255], v[172:175], v[44:47], v[252:255]
    s_waitcnt vmcnt(12)
    v_mfma_f32_16x16x32_bf16 v[192:195], v[176:179], v[96:99], v[192:195]
    s_lshl_b32 s29, s38, 10
    s_add_u32 s29, s30, s29
    s_add_u32 s38, s38, 1
    s_cmp_eq_u32 s38, 14
    s_cselect_b32 s38, 0, s38
    buffer_load_dwordx4 v[128:131], v48, s[12:15], s29 offen sc1
    buffer_load_dwordx4 v[132:135], v49, s[12:15], s29 offen sc1
    v_mfma_f32_16x16x32_bf16 v[196:199], v[176:179], v[100:103], v[196:199]
    ds_read_b64_tr_b16 v[144:145], v60 offset:0
    v_mfma_f32_16x16x32_bf16 v[200:203], v[176:179], v[104:107], v[200:203]
    ds_read_b64_tr_b16 v[146:147], v60 offset:512
    v_mfma_f32_16x16x32_bf16 v[204:207], v[176:179], v[108:111], v[204:207]
    ds_read_b64_tr_b16 v[148:149], v61 offset:0
    v_mfma_f32_16x16x32_bf16 v[208:211], v[180:183], v[96:99], v[208:211]
    ds_read_b64_tr_b16 v[150:151], v61 offset:512
    v_mfma_f32_16x16x32_bf16 v[212:215], v[180:183], v[100:103], v[212:215]
    ds_read_b64_tr_b16 v[152:153], v62 offset:0
    v_mfma_f32_16x16x32_bf16 v[216:219], v[180:183], v[104:107], v[216:219]
    ds_read_b64_tr_b16 v[154:155], v62 offset:512
    v_mfma_f32_16x16x32_bf16 v[220:223], v[180:183], v[108:111], v[220:223]
    ds_read_b64_tr_b16 v[156:157], v63 offset:0
    v_mfma_f32_16x16x32_bf16 v[224:227], v[184:187], v[96:99], v[224:227]
    buffer_load_dwordx4 v[136:139], v50, s[12:15], s29 offen sc1
    buffer_load_dwordx4 v[140:143], v51, s[12:15], s29 offen sc1
    v_mfma_f32_16x16x32_bf16 v[228:231], v[184:187], v[100:103], v[228:231]
    ds_read_b64_tr_b16 v[158:159], v63 offset:512
    v_mfma_f32_16x16x32_bf16 v[232:235], v[184:187], v[104:107], v[232:235]
    v_mfma_f32_16x16x32_bf16 v[236:239], v[184:187], v[108:111], v[236:239]
    v_mfma_f32_16x16x32_bf16 v[240:243], v[188:191], v[96:99], v[240:243]
    v_mfma_f32_16x16x32_bf16 v[244:247], v[188:191], v[100:103], v[244:247]
    v_mfma_f32_16x16x32_bf16 v[248:251], v[188:191], v[104:107], v[248:251]
    v_mfma_f32_16x16x32_bf16 v[252:255], v[188:191], v[108:111], v[252:255]
    s_waitcnt vmcnt(12)
    s_waitcnt lgkmcnt(0)
    v_mfma_f32_16x16x32_bf16 v[192:195], v[144:147], v[64:67], v[192:195]
    s_lshl_b32 s18, s38, 10
    s_add_u32 s18, s30, s18
    s_add_u32 s38, s38, 1
    s_cmp_eq_u32 s38, 14
    s_cselect_b32 s38, 0, s38
    s_lshl_b32 s19, s38, 10
    s_add_u32 s19, s30, s19
    s_add_u32 s38, s38, 1
    s_cmp_eq_u32 s38, 14
    s_cselect_b32 s38, 0, s38
    s_lshl_b32 s20, s38, 10
    s_add_u32 s20, s30, s20
    s_add_u32 s38, s38, 1
    s_cmp_eq_u32 s38, 14
    s_cselect_b32 s38, 0, s38
    buffer_load_dwordx4 v[80:83], v48, s[12:15], s18 offen sc1
    buffer_load_dwordx4 v[84:87], v48, s[12:15], s19 offen sc1
    buffer_load_dwordx4 v[88:91], v48, s[12:15], s20 offen sc1
    buffer_load_dwordx4 v[92:95], v49, s[12:15], s18 offen sc1
    v_mfma_f32_16x16x32_bf16 v[196:199], v[144:147], v[68:71], v[196:199]
    ds_read_b64_tr_b16 v[160:161], v56 offset:16384
    v_mfma_f32_16x16x32_bf16 v[200:203], v[144:147], v[72:75], v[200:203]
    ds_read_b64_tr_b16 v[162:163], v56 offset:16896
    v_mfma_f32_16x16x32_bf16 v[204:207], v[144:147], v[76:79], v[204:207]
    ds_read_b64_tr_b16 v[164:165], v57 offset:16384
    v_mfma_f32_16x16x32_bf16 v[208:211], v[148:151], v[64:67], v[208:211]
    ds_read_b64_tr_b16 v[166:167], v57 offset:16896
    v_mfma_f32_16x16x32_bf16 v[212:215], v[148:151], v[68:71], v[212:215]
    ds_read_b64_tr_b16 v[168:169], v58 offset:16384
    v_mfma_f32_16x16x32_bf16 v[216:219], v[148:151], v[72:75], v[216:219]
    ds_read_b64_tr_b16 v[170:171], v58 offset:16896
    v_mfma_f32_16x16x32_bf16 v[220:223], v[148:151], v[76:79], v[220:223]
    ds_read_b64_tr_b16 v[172:173], v59 offset:16384
    v_mfma_f32_16x16x32_bf16 v[224:227], v[152:155], v[64:67], v[224:227]
    s_add_u32 m0, s67, 65536
    s_lshl_b32 s28, s39, 15
    s_add_u32 s28, s31, s28
    s_add_u32 s39, s39, 1
    s_cmp_eq_u32 s39, 14
    s_cselect_b32 s39, 0, s39
    buffer_load_dwordx4 v52, s[44:47], s28 offen offset:0 lds
    buffer_load_dwordx4 v53, s[44:47], s28 offen offset:1024 lds
    buffer_load_dwordx4 v54, s[44:47], s28 offen offset:2048 lds
    buffer_load_dwordx4 v55, s[44:47], s28 offen offset:3072 lds
    v_mfma_f32_16x16x32_bf16 v[228:231], v[152:155], v[68:71], v[228:231]
    ds_read_b64_tr_b16 v[174:175], v59 offset:16896
    v_mfma_f32_16x16x32_bf16 v[232:235], v[152:155], v[72:75], v[232:235]
    v_mfma_f32_16x16x32_bf16 v[236:239], v[152:155], v[76:79], v[236:239]
    v_mfma_f32_16x16x32_bf16 v[240:243], v[156:159], v[64:67], v[240:243]
    v_mfma_f32_16x16x32_bf16 v[244:247], v[156:159], v[68:71], v[244:247]
    v_mfma_f32_16x16x32_bf16 v[248:251], v[156:159], v[72:75], v[248:251]
    v_mfma_f32_16x16x32_bf16 v[252:255], v[156:159], v[76:79], v[252:255]
    s_waitcnt vmcnt(16)
    s_waitcnt lgkmcnt(0)
    v_mfma_f32_16x16x32_bf16 v[192:195], v[160:163], v[112:115], v[192:195]
    buffer_load_dwordx4 v[32:35], v49, s[12:15], s19 offen sc1
    buffer_load_dwordx4 v[36:39], v49, s[12:15], s20 offen sc1
    v_mfma_f32_16x16x32_bf16 v[196:199], v[160:163], v[116:119], v[196:199]
    ds_read_b64_tr_b16 v[176:177], v60 offset:16384
    v_mfma_f32_16x16x32_bf16 v[200:203], v[160:163], v[120:123], v[200:203]
    ds_read_b64_tr_b16 v[178:179], v60 offset:16896
    v_mfma_f32_16x16x32_bf16 v[204:207], v[160:163], v[124:127], v[204:207]
    ds_read_b64_tr_b16 v[180:181], v61 offset:16384
    v_mfma_f32_16x16x32_bf16 v[208:211], v[164:167], v[112:115], v[208:211]
    ds_read_b64_tr_b16 v[182:183], v61 offset:16896
    v_mfma_f32_16x16x32_bf16 v[212:215], v[164:167], v[116:119], v[212:215]
    ds_read_b64_tr_b16 v[184:185], v62 offset:16384
    v_mfma_f32_16x16x32_bf16 v[216:219], v[164:167], v[120:123], v[216:219]
    ds_read_b64_tr_b16 v[186:187], v62 offset:16896
    v_mfma_f32_16x16x32_bf16 v[220:223], v[164:167], v[124:127], v[220:223]
    ds_read_b64_tr_b16 v[188:189], v63 offset:16384
    v_mfma_f32_16x16x32_bf16 v[224:227], v[168:171], v[112:115], v[224:227]
    buffer_load_dwordx4 v[40:43], v50, s[12:15], s18 offen sc1
    buffer_load_dwordx4 v[44:47], v50, s[12:15], s19 offen sc1
    v_mfma_f32_16x16x32_bf16 v[228:231], v[168:171], v[116:119], v[228:231]
    ds_read_b64_tr_b16 v[190:191], v63 offset:16896
    v_mfma_f32_16x16x32_bf16 v[232:235], v[168:171], v[120:123], v[232:235]
    v_mfma_f32_16x16x32_bf16 v[236:239], v[168:171], v[124:127], v[236:239]
    v_mfma_f32_16x16x32_bf16 v[240:243], v[172:175], v[112:115], v[240:243]
    v_mfma_f32_16x16x32_bf16 v[244:247], v[172:175], v[116:119], v[244:247]
    v_mfma_f32_16x16x32_bf16 v[248:251], v[172:175], v[120:123], v[248:251]
    v_mfma_f32_16x16x32_bf16 v[252:255], v[172:175], v[124:127], v[252:255]
    s_waitcnt vmcnt(16)
    s_waitcnt lgkmcnt(0)
    v_mfma_f32_16x16x32_bf16 v[192:195], v[176:179], v[16:19], v[192:195]
    buffer_load_dwordx4 v[96:99], v50, s[12:15], s20 offen sc1
    buffer_load_dwordx4 v[100:103], v51, s[12:15], s18 offen sc1
    v_mfma_f32_16x16x32_bf16 v[196:199], v[176:179], v[20:23], v[196:199]
    ds_read_b64_tr_b16 v[144:145], v56 offset:32768
    v_mfma_f32_16x16x32_bf16 v[200:203], v[176:179], v[24:27], v[200:203]
    ds_read_b64_tr_b16 v[146:147], v56 offset:33280
    v_mfma_f32_16x16x32_bf16 v[204:207], v[176:179], v[28:31], v[204:207]
    ds_read_b64_tr_b16 v[148:149], v57 offset:32768
    v_mfma_f32_16x16x32_bf16 v[208:211], v[180:183], v[16:19], v[208:211]
    ds_read_b64_tr_b16 v[150:151], v57 offset:33280
    v_mfma_f32_16x16x32_bf16 v[212:215], v[180:183], v[20:23], v[212:215]
    ds_read_b64_tr_b16 v[152:153], v58 offset:32768
    v_mfma_f32_16x16x32_bf16 v[216:219], v[180:183], v[24:27], v[216:219]
    ds_read_b64_tr_b16 v[154:155], v58 offset:33280
    v_mfma_f32_16x16x32_bf16 v[220:223], v[180:183], v[28:31], v[220:223]
    ds_read_b64_tr_b16 v[156:157], v59 offset:32768
    v_mfma_f32_16x16x32_bf16 v[224:227], v[184:187], v[16:19], v[224:227]
    buffer_load_dwordx4 v[104:107], v51, s[12:15], s19 offen sc1
    buffer_load_dwordx4 v[108:111], v51, s[12:15], s20 offen sc1
    v_mfma_f32_16x16x32_bf16 v[228:231], v[184:187], v[20:23], v[228:231]
    ds_read_b64_tr_b16 v[158:159], v59 offset:33280
    v_mfma_f32_16x16x32_bf16 v[232:235], v[184:187], v[24:27], v[232:235]
    v_mfma_f32_16x16x32_bf16 v[236:239], v[184:187], v[28:31], v[236:239]
    v_mfma_f32_16x16x32_bf16 v[240:243], v[188:191], v[16:19], v[240:243]
    v_mfma_f32_16x16x32_bf16 v[244:247], v[188:191], v[20:23], v[244:247]
    v_mfma_f32_16x16x32_bf16 v[248:251], v[188:191], v[24:27], v[248:251]
    v_mfma_f32_16x16x32_bf16 v[252:255], v[188:191], v[28:31], v[252:255]
    ds_write_b32 v6, v7 offset:28
    s_waitcnt vmcnt(16)
    s_waitcnt lgkmcnt(0)
    s_waitcnt vmcnt(8)
    v_mfma_f32_16x16x32_bf16 v[192:195], v[144:147], v[128:131], v[192:195]
    v_mfma_f32_16x16x32_bf16 v[196:199], v[144:147], v[132:135], v[196:199]
    ds_read_b64_tr_b16 v[160:161], v60 offset:32768
    ds_read_b64_tr_b16 v[162:163], v60 offset:33280
    v_mfma_f32_16x16x32_bf16 v[200:203], v[144:147], v[136:139], v[200:203]
    ds_read_b64_tr_b16 v[164:165], v61 offset:32768
    ds_read_b64_tr_b16 v[166:167], v61 offset:33280
    v_mfma_f32_16x16x32_bf16 v[204:207], v[144:147], v[140:143], v[204:207]
    ds_read_b64_tr_b16 v[168:169], v62 offset:32768
    ds_read_b64_tr_b16 v[170:171], v62 offset:33280
    v_mfma_f32_16x16x32_bf16 v[208:211], v[148:151], v[128:131], v[208:211]
    ds_read_b64_tr_b16 v[172:173], v63 offset:32768
    ds_read_b64_tr_b16 v[174:175], v63 offset:33280
    v_mfma_f32_16x16x32_bf16 v[212:215], v[148:151], v[132:135], v[212:215]
    ds_read_b64_tr_b16 v[176:177], v56 offset:0
    ds_read_b64_tr_b16 v[178:179], v56 offset:512
    v_mfma_f32_16x16x32_bf16 v[216:219], v[148:151], v[136:139], v[216:219]
    ds_read_b64_tr_b16 v[180:181], v57 offset:0
    ds_read_b64_tr_b16 v[182:183], v57 offset:512
    v_mfma_f32_16x16x32_bf16 v[220:223], v[148:151], v[140:143], v[220:223]
    ds_read_b64_tr_b16 v[184:185], v58 offset:0
    ds_read_b64_tr_b16 v[186:187], v58 offset:512
    v_mfma_f32_16x16x32_bf16 v[224:227], v[152:155], v[128:131], v[224:227]
    v_mfma_f32_16x16x32_bf16 v[228:231], v[152:155], v[132:135], v[228:231]
    ds_read_b64_tr_b16 v[188:189], v59 offset:0
    ds_read_b64_tr_b16 v[190:191], v59 offset:512
    v_mfma_f32_16x16x32_bf16 v[232:235], v[152:155], v[136:139], v[232:235]
    ds_read_b64_tr_b16 v[64:65], v60 offset:0
    ds_read_b64_tr_b16 v[66:67], v60 offset:512
    v_mfma_f32_16x16x32_bf16 v[236:239], v[152:155], v[140:143], v[236:239]
    ds_read_b64_tr_b16 v[68:69], v61 offset:0
    ds_read_b64_tr_b16 v[70:71], v61 offset:512
    v_mfma_f32_16x16x32_bf16 v[240:243], v[156:159], v[128:131], v[240:243]
    ds_read_b64_tr_b16 v[72:73], v62 offset:0
    ds_read_b64_tr_b16 v[74:75], v62 offset:512
    v_mfma_f32_16x16x32_bf16 v[244:247], v[156:159], v[132:135], v[244:247]
    ds_read_b64_tr_b16 v[76:77], v63 offset:0
    ds_read_b64_tr_b16 v[78:79], v63 offset:512
    v_mfma_f32_16x16x32_bf16 v[248:251], v[156:159], v[136:139], v[248:251]
    v_mfma_f32_16x16x32_bf16 v[252:255], v[156:159], v[140:143], v[252:255]
    s_waitcnt lgkmcnt(0)
    v_mfma_f32_16x16x32_bf16 v[192:195], v[160:163], v[80:83], v[192:195]
    v_mfma_f32_16x16x32_bf16 v[208:211], v[164:167], v[80:83], v[208:211]
    v_mfma_f32_16x16x32_bf16 v[224:227], v[168:171], v[80:83], v[224:227]
    v_mfma_f32_16x16x32_bf16 v[240:243], v[172:175], v[80:83], v[240:243]
    v_mfma_f32_16x16x32_bf16 v[192:195], v[176:179], v[84:87], v[192:195]
    v_mfma_f32_16x16x32_bf16 v[208:211], v[180:183], v[84:87], v[208:211]
    v_mfma_f32_16x16x32_bf16 v[224:227], v[184:187], v[84:87], v[224:227]
    v_mfma_f32_16x16x32_bf16 v[240:243], v[188:191], v[84:87], v[240:243]
    v_mfma_f32_16x16x32_bf16 v[192:195], v[64:67], v[88:91], v[192:195]
    v_mfma_f32_16x16x32_bf16 v[208:211], v[68:71], v[88:91], v[208:211]
    v_mfma_f32_16x16x32_bf16 v[224:227], v[72:75], v[88:91], v[224:227]
    v_mfma_f32_16x16x32_bf16 v[240:243], v[76:79], v[88:91], v[240:243]
    s_waitcnt vmcnt(6)
    v_mfma_f32_16x16x32_bf16 v[196:199], v[160:163], v[92:95], v[196:199]
    v_mfma_f32_16x16x32_bf16 v[212:215], v[164:167], v[92:95], v[212:215]
    v_mfma_f32_16x16x32_bf16 v[228:231], v[168:171], v[92:95], v[228:231]
    s_nop 0
    ds_write_b128 v2, v[192:195] offset:0
    v_mfma_f32_16x16x32_bf16 v[244:247], v[172:175], v[92:95], v[244:247]
    ds_write_b128 v3, v[208:211] offset:0
    v_mfma_f32_16x16x32_bf16 v[196:199], v[176:179], v[32:35], v[196:199]
    ds_write_b128 v4, v[224:227] offset:0
    v_mfma_f32_16x16x32_bf16 v[212:215], v[180:183], v[32:35], v[212:215]
    ds_write_b128 v5, v[240:243] offset:0
    v_mfma_f32_16x16x32_bf16 v[228:231], v[184:187], v[32:35], v[228:231]
    v_mfma_f32_16x16x32_bf16 v[244:247], v[188:191], v[32:35], v[244:247]
    v_mfma_f32_16x16x32_bf16 v[196:199], v[64:67], v[36:39], v[196:199]
    v_mfma_f32_16x16x32_bf16 v[212:215], v[68:71], v[36:39], v[212:215]
    v_mfma_f32_16x16x32_bf16 v[228:231], v[72:75], v[36:39], v[228:231]
    v_mfma_f32_16x16x32_bf16 v[244:247], v[76:79], v[36:39], v[244:247]
    s_waitcnt vmcnt(3)
    v_mfma_f32_16x16x32_bf16 v[200:203], v[160:163], v[40:43], v[200:203]
    v_mfma_f32_16x16x32_bf16 v[216:219], v[164:167], v[40:43], v[216:219]
    v_mfma_f32_16x16x32_bf16 v[232:235], v[168:171], v[40:43], v[232:235]
    s_nop 0
    ds_write_b128 v2, v[196:199] offset:16384
    v_mfma_f32_16x16x32_bf16 v[248:251], v[172:175], v[40:43], v[248:251]
    ds_write_b128 v3, v[212:215] offset:16384
    v_mfma_f32_16x16x32_bf16 v[200:203], v[176:179], v[44:47], v[200:203]
    ds_write_b128 v4, v[228:231] offset:16384
    v_mfma_f32_16x16x32_bf16 v[216:219], v[180:183], v[44:47], v[216:219]
    ds_write_b128 v5, v[244:247] offset:16384
    v_mfma_f32_16x16x32_bf16 v[232:235], v[184:187], v[44:47], v[232:235]
    v_mfma_f32_16x16x32_bf16 v[248:251], v[188:191], v[44:47], v[248:251]
    v_mfma_f32_16x16x32_bf16 v[200:203], v[64:67], v[96:99], v[200:203]
    v_mfma_f32_16x16x32_bf16 v[216:219], v[68:71], v[96:99], v[216:219]
    v_mfma_f32_16x16x32_bf16 v[232:235], v[72:75], v[96:99], v[232:235]
    v_mfma_f32_16x16x32_bf16 v[248:251], v[76:79], v[96:99], v[248:251]
    s_waitcnt vmcnt(0)
    v_mfma_f32_16x16x32_bf16 v[204:207], v[160:163], v[100:103], v[204:207]
    v_mfma_f32_16x16x32_bf16 v[220:223], v[164:167], v[100:103], v[220:223]
    v_mfma_f32_16x16x32_bf16 v[236:239], v[168:171], v[100:103], v[236:239]
    s_nop 0
    ds_write_b128 v2, v[200:203] offset:32768
    v_mfma_f32_16x16x32_bf16 v[252:255], v[172:175], v[100:103], v[252:255]
    ds_write_b128 v3, v[216:219] offset:32768
    v_mfma_f32_16x16x32_bf16 v[204:207], v[176:179], v[104:107], v[204:207]
    ds_write_b128 v4, v[232:235] offset:32768
    v_mfma_f32_16x16x32_bf16 v[220:223], v[180:183], v[104:107], v[220:223]
    ds_write_b128 v5, v[248:251] offset:32768
    v_mfma_f32_16x16x32_bf16 v[236:239], v[184:187], v[104:107], v[236:239]
    v_mfma_f32_16x16x32_bf16 v[252:255], v[188:191], v[104:107], v[252:255]
    v_mfma_f32_16x16x32_bf16 v[204:207], v[64:67], v[108:111], v[204:207]
    v_mfma_f32_16x16x32_bf16 v[220:223], v[68:71], v[108:111], v[220:223]
    v_mfma_f32_16x16x32_bf16 v[236:239], v[72:75], v[108:111], v[236:239]
    v_mfma_f32_16x16x32_bf16 v[252:255], v[76:79], v[108:111], v[252:255]
    s_nop 4
    ds_write_b128 v2, v[204:207] offset:49152
    ds_write_b128 v3, v[220:223] offset:49152
    ds_write_b128 v4, v[236:239] offset:49152
    ds_write_b128 v5, v[252:255] offset:49152
L_FINAL:
    s_mov_b32 s30, 0xbfb8aa3b
    s_mov_b32 s31, 0xbfb8aa3b
    s_waitcnt vmcnt(0) lgkmcnt(0)
    s_barrier
    ds_read_b128 v[16:19], v14 offset:0
    ds_read_b128 v[20:23], v15 offset:0
    ds_read_b128 v[24:27], v14 offset:4096
    ds_read_b128 v[28:31], v15 offset:4096
    ds_read_b128 v[32:35], v14 offset:8192
    ds_read_b128 v[36:39], v15 offset:8192
    ds_read_b128 v[40:43], v14 offset:12288
    ds_read_b128 v[44:47], v15 offset:12288
    ds_read_b128 v[48:51], v13
    v_lshlrev_b32 v60, 16, v8
    v_and_b32 v61, 0xffff0000, v8
    v_lshlrev_b32 v62, 16, v9
    v_and_b32 v63, 0xffff0000, v9
    v_lshlrev_b32 v64, 16, v10
    v_and_b32 v65, 0xffff0000, v10
    v_lshlrev_b32 v66, 16, v11
    v_and_b32 v67, 0xffff0000, v11
    s_waitcnt lgkmcnt(5)
    v_pk_add_f32 v[16:17], v[16:17], v[24:25]
    v_pk_add_f32 v[18:19], v[18:19], v[26:27]
    v_pk_add_f32 v[20:21], v[20:21], v[28:29]
    v_pk_add_f32 v[22:23], v[22:23], v[30:31]
    s_waitcnt lgkmcnt(1)
    v_pk_add_f32 v[32:33], v[32:33], v[40:41]
    v_pk_add_f32 v[34:35], v[34:35], v[42:43]
    v_pk_add_f32 v[36:37], v[36:37], v[44:45]
    v_pk_add_f32 v[38:39], v[38:39], v[46:47]
    v_pk_add_f32 v[16:17], v[16:17], v[32:33]
    v_pk_add_f32 v[18:19], v[18:19], v[34:35]
    v_pk_add_f32 v[20:21], v[20:21], v[36:37]
    v_pk_add_f32 v[22:23], v[22:23], v[38:39]
    v_pk_mul_f32 v[52:53], v[16:17], s[30:31]
    v_pk_mul_f32 v[54:55], v[18:19], s[30:31]
    v_pk_mul_f32 v[56:57], v[20:21], s[30:31]
    v_pk_mul_f32 v[58:59], v[22:23], s[30:31]
    v_exp_f32 v52, v52
    v_exp_f32 v53, v53
    v_exp_f32 v54, v54
    v_exp_f32 v55, v55
    v_exp_f32 v56, v56
    v_exp_f32 v57, v57
    v_exp_f32 v58, v58
    v_exp_f32 v59, v59
    v_pk_add_f32 v[52:53], v[52:53], 1.0 op_sel_hi:[1,0]
    v_pk_add_f32 v[54:55], v[54:55], 1.0 op_sel_hi:[1,0]
    v_pk_add_f32 v[56:57], v[56:57], 1.0 op_sel_hi:[1,0]
    v_pk_add_f32 v[58:59], v[58:59], 1.0 op_sel_hi:[1,0]
    v_rcp_f32 v52, v52
    v_rcp_f32 v53, v53
    v_rcp_f32 v54, v54
    v_rcp_f32 v55, v55
    v_rcp_f32 v56, v56
    v_rcp_f32 v57, v57
    v_rcp_f32 v58, v58
    v_rcp_f32 v59, v59
    s_waitcnt lgkmcnt(0)
    v_lshlrev_b32 v68, 16, v48
    v_and_b32 v69, 0xffff0000, v48
    v_lshlrev_b32 v70, 16, v49
    v_and_b32 v71, 0xffff0000, v49
    v_lshlrev_b32 v72, 16, v50
    v_and_b32 v73, 0xffff0000, v50
    v_lshlrev_b32 v74, 16, v51
    v_and_b32 v75, 0xffff0000, v51
    v_pk_mul_f32 v[16:17], v[16:17], v[52:53]
    v_pk_mul_f32 v[18:19], v[18:19], v[54:55]
    v_pk_mul_f32 v[20:21], v[20:21], v[56:57]
    v_pk_mul_f32 v[22:23], v[22:23], v[58:59]
    v_pk_fma_f32 v[16:17], v[16:17], v[68:69], v[60:61]
    v_pk_fma_f32 v[18:19], v[18:19], v[70:71], v[62:63]
    v_pk_fma_f32 v[20:21], v[20:21], v[72:73], v[64:65]
    v_pk_fma_f32 v[22:23], v[22:23], v[74:75], v[66:67]
    v_cvt_pk_bf16_f32 v48, v16, v17
    v_cvt_pk_bf16_f32 v49, v18, v19
    v_cvt_pk_bf16_f32 v50, v20, v21
    v_cvt_pk_bf16_f32 v51, v22, v23
    buffer_store_dwordx4 v[48:51], v12, s[48:51], 0 offen sc1
L_END:
    s_endpgm
L_CODE_END:
.section .rodata,"a"
.p2align 6
.amdhsa_kernel recurrent_scan__ssm_conv_s4d__dense_activation_silu__prompt_kernel
  .amdhsa_next_free_vgpr 256
  .amdhsa_next_free_sgpr 102
  .amdhsa_accum_offset 256
  .amdhsa_group_segment_fixed_size 0
  .amdhsa_kernarg_size 104
  .amdhsa_user_sgpr_count 2
  .amdhsa_user_sgpr_kernarg_segment_ptr 1
  .amdhsa_system_sgpr_workgroup_id_x 1
.end_amdhsa_kernel
```
